```python
import torch

def _softmax(x, axis=-1):
    return torch.softmax(x, dim=axis)
def _gelu(x):
    return torch.nn.functional.gelu(x, approximate="tanh")
def _silu(x):
    return torch.nn.functional.silu(x)
def _sigmoid(x):
    return torch.sigmoid(x)
def _layernorm(x, axis=-1, eps=1e-5):
    m = x.mean(dim=axis, keepdim=True)
    v = x.var(dim=axis, keepdim=True, unbiased=False)
    return (x - m) / torch.sqrt(v + eps)
def _scatter_add(tgt, idx, src, axis=0):
    return tgt.clone().index_add_(axis, idx, src)
def _segment_sum(src, seg, n):
    out = torch.zeros((n,) + src.shape[1:], dtype=src.dtype)
    return out.index_add_(0, seg, src)
def _pad(x, pw):
    flat = tuple(v for pair in reversed(pw) for v in pair)
    return torch.nn.functional.pad(x, flat)

kernel_name = 'standalone__gqa_softmax__near_ridge'

def setup_inputs():

    _w = (lambda a: (lambda t: t.to(torch.bfloat16) if t.is_floating_point() else t)(torch.as_tensor(a)))
    B, Hq, Hkv, Sq, Sk, D = 8, 16, 8, 96, 1024, 256
    return {
        "q": _w((lambda *s: torch.randn(*s, dtype=torch.bfloat16) * 0.8)(B, Hq, Sq, D)),
        "k": _w((lambda *s: torch.randn(*s, dtype=torch.bfloat16) * 0.8)(B, Hkv, Sk, D)),
        "v": _w((lambda *s: torch.randn(*s, dtype=torch.bfloat16) * 0.05)(B, Hkv, Sk, D)),
    }

def reference(q, k, v):
    B, Hq, Sq, D = q.shape
    Hkv = k.shape[1]
    rep = Hq // Hkv
    k = (lambda x, n, axis: torch.repeat_interleave(x, n, dim=axis))(k, rep, axis=1)
    v = (lambda x, n, axis: torch.repeat_interleave(x, n, dim=axis))(v, rep, axis=1)
    scale = D ** -0.5
    scores = torch.einsum("bhqd,bhkd->bhqk", q, k) * scale
    p = _softmax(scores, axis=-1)
    return torch.einsum("bhqk,bhkd->bhqd", p, v)
```

```asm
; @launch grid=(256,1,1) block=(256,1,1) lds=163840
.amdgcn_target "amdgcn-amd-amdhsa--gfx950"
.text
.globl standalone__gqa_softmax__near_ridge_kernel
.p2align 8
.type standalone__gqa_softmax__near_ridge_kernel,@function
standalone__gqa_softmax__near_ridge_kernel:
    s_cmp_ge_u32 s2, 256
    s_cbranch_scc1 L_end
    s_memrealtime s[40:41]
    s_load_dwordx4 s[4:7], s[0:1], 0
    s_load_dwordx4 s[8:11], s[0:1], 16
    s_load_dwordx4 s[56:59], s[0:1], 32
    s_getpc_b64 s[36:37]
    v_lshlrev_b32 v28, 7, v0
    v_min_u32 v28, L_nonce - L_pc, v28
L_pc:
    global_load_dword v25, v28, s[36:37]
    v_lshrrev_b32 v30, 6, v0
    v_and_b32 v0, 63, v0
    v_readfirstlane_b32 s3, v30
    s_and_b32 s47, s2, 7
    s_lshr_b32 s39, s2, 5
    s_lshl_b32 s39, s39, 3
    s_add_u32 s47, s47, s39
    s_bfe_u32 s52, s2, 0x20003
    s_and_b32 s39, s52, 1
    s_lshl_b32 s38, s47, 1
    s_add_u32 s38, s38, s39
    s_mul_i32 s33, s38, 49152
    s_lshr_b32 s45, s52, 1
    s_lshl_b32 s43, s47, 19
    s_lshl_b32 s38, s45, 18
    s_add_u32 s43, s43, s38
    s_and_b32 s35, s3, 1
    s_lshr_b32 s46, s3, 1
    s_lshl_b32 s38, s46, 13
    s_add_u32 s43, s43, s38
    s_lshl_b32 s38, s35, 12
    s_add_u32 s28, s43, s38
    s_mul_i32 s30, s46, 81920
    s_add_u32 s29, s30, s38
    v_lshrrev_b32 v30, 5, v0
    v_and_b32 v31, 31, v0
    v_lshlrev_b32 v32, 1, v30
    v_xor_b32 v31, v31, v32
    v_lshlrev_b32 v31, 4, v31
    v_lshl_add_u32 v1, v30, 9, v31
    v_xor_b32 v2, 64, v1
    v_xor_b32 v3, 128, v1
    v_xor_b32 v4, 192, v1
    s_lshl_b32 s38, s35, 7
    v_xor_b32 v33, s38, v1
    v_xor_b32 v34, s38, v2
    s_lshl_b32 s39, s3, 11
    s_add_u32 s31, s33, s39
    s_waitcnt lgkmcnt(0)
    s_mov_b32 s12, s4
    s_mov_b32 s13, s5
    s_mov_b32 s14, 6291456
    s_mov_b32 s15, 0x20000
    s_mov_b32 s16, s6
    s_mov_b32 s17, s7
    s_mov_b32 s18, 0x2000000
    s_mov_b32 s19, 0x20000
    s_add_u32 m0, s39, 49152
    s_nop 0
    buffer_load_dwordx4 v33, s[12:15], s31 offen  lds
    buffer_load_dwordx4 v34, s[12:15], s31 offen offset:1024  lds
    s_add_u32 m0, s39, 57344
    s_add_u32 s31, s31, 8192
    buffer_load_dwordx4 v33, s[12:15], s31 offen  lds
    buffer_load_dwordx4 v34, s[12:15], s31 offen offset:1024  lds
    s_add_u32 m0, s39, 65536
    s_add_u32 s31, s31, 8192
    buffer_load_dwordx4 v33, s[12:15], s31 offen  lds
    buffer_load_dwordx4 v34, s[12:15], s31 offen offset:1024  lds
    s_add_u32 m0, s39, 131072
    s_add_u32 s31, s31, 8192
    buffer_load_dwordx4 v33, s[12:15], s31 offen  lds
    buffer_load_dwordx4 v34, s[12:15], s31 offen offset:1024  lds
    s_add_u32 m0, s39, 139264
    s_add_u32 s31, s31, 8192
    buffer_load_dwordx4 v33, s[12:15], s31 offen  lds
    buffer_load_dwordx4 v34, s[12:15], s31 offen offset:1024  lds
    s_add_u32 m0, s39, 147456
    s_add_u32 s31, s31, 8192
    buffer_load_dwordx4 v33, s[12:15], s31 offen  lds
    buffer_load_dwordx4 v34, s[12:15], s31 offen offset:1024  lds
    s_add_u32 m0, s29, 0
    s_add_u32 s31, s28, 0
    buffer_load_dwordx4 v1, s[16:19], s31 offen nt lds
    buffer_load_dwordx4 v2, s[16:19], s31 offen offset:1024 nt lds
    buffer_load_dwordx4 v3, s[16:19], s31 offen offset:2048 nt lds
    buffer_load_dwordx4 v4, s[16:19], s31 offen offset:3072 nt lds
    s_add_u32 m0, s29, 8192
    s_add_u32 s31, s28, 16384
    buffer_load_dwordx4 v1, s[16:19], s31 offen nt lds
    buffer_load_dwordx4 v2, s[16:19], s31 offen offset:1024 nt lds
    buffer_load_dwordx4 v3, s[16:19], s31 offen offset:2048 nt lds
    buffer_load_dwordx4 v4, s[16:19], s31 offen offset:3072 nt lds
    s_mov_b32 s20, s8
    s_mov_b32 s21, s9
    s_mov_b32 s22, 0x2000000
    s_mov_b32 s23, 0x20000
    s_mov_b32 s24, s10
    s_mov_b32 s25, s11
    s_mov_b32 s26, 6291456
    s_mov_b32 s27, 0x20000
    s_mov_b32 s48, s58
    s_mov_b32 s49, s59
    s_mov_b32 s50, 8912896
    s_mov_b32 s51, 0x20000
    s_mov_b32 s32, 0x3db8aa3b
    s_mov_b32 s44, 0xff7fffff
    s_mov_b32 s8, 0xffff0000
    s_mov_b32 s9, 0x41800000
    s_lshl_b32 s34, s45, 1
    s_add_u32 s34, s34, s46
    s_lshl_b32 s34, s34, 7
    s_lshl_b32 s38, s35, 15
    s_add_u32 s43, s43, s38
    s_add_u32 s60, s43, s34
    s_xor_b32 s61, s60, 128
    s_xor_b32 s62, s60, 256
    s_xor_b32 s63, s60, 384
    s_lshl_b32 s38, s2, 2
    s_add_u32 s38, s38, s3
    s_lshl_b32 s53, s38, 13
    s_xor_b32 s54, s53, 524288
    s_add_u32 s4, s53, 4096
    s_add_u32 s5, s54, 4096
    s_lshl_b32 s38, s38, 9
    s_add_u32 s6, s38, 8388608
    s_xor_b32 s7, s6, 32768
    s_mul_i32 s38, s35, 24576
    s_add_u32 s42, s33, s38
    s_add_u32 s42, s42, s34
    s_xor_b32 s45, s42, 256
    s_getreg_b32 s10, hwreg(HW_REG_XCC_ID, 0, 4)
    s_lshl_b32 s10, s10, 28
    v_lshrrev_b32 v39, 3, v0
    v_and_b32 v40, 7, v0
    v_lshlrev_b32 v40, 4, v40
    v_lshl_add_u32 v59, v39, 9, v40
    s_lshl_b32 s38, s47, 2
    v_mov_b32 v26, 0
    v_mov_b32 v52, s38
    s_or_b32 s38, s52, s3
    s_cmp_eq_u32 s38, 0
    s_cbranch_scc0 L_nopub
    s_or_b32 s38, s40, 1
    v_mov_b32 v46, s38
    global_store_dword v52, v46, s[56:57] sc1
L_nopub:
    v_and_b32 v30, 15, v0
    v_lshrrev_b32 v31, 4, v0
    v_and_b32 v32, 7, v0
    v_lshlrev_b32 v32, 1, v32
    v_xor_b32 v32, v32, v31
    v_lshlrev_b32 v32, 4, v32
    v_lshl_add_u32 v35, v30, 9, v32
    v_xor_b32 v36, 64, v35
    v_xor_b32 v37, 128, v35
    v_xor_b32 v38, 192, v35
    s_mul_i32 s38, s35, 81920
    s_add_u32 s38, s38, 49152
    v_add_u32 v5, s30, v35
    v_add_u32 v35, s38, v35
    v_add_u32 v6, s30, v36
    v_add_u32 v36, s38, v36
    v_add_u32 v7, s30, v37
    v_add_u32 v37, s38, v37
    v_add_u32 v8, s30, v38
    v_add_u32 v38, s38, v38
    v_lshlrev_b32 v57, 4, v30
    v_lshlrev_b32 v27, 4, v0
    v_lshrrev_b32 v39, 1, v31
    v_and_b32 v40, 1, v31
    v_lshlrev_b32 v40, 5, v40
    v_lshl_add_u32 v58, v39, 4, v40
    v_lshl_add_u32 v58, v30, 9, v58
    s_mul_i32 s38, s35, 12288
    s_add_u32 s38, s38, 49152
    s_add_u32 s39, s38, s30
    v_add_u32 v55, s39, v27
    s_xor_b32 s55, s46, 1
    s_mul_i32 s55, s55, 81920
    s_add_u32 s39, s38, s55
    v_add_u32 v56, s39, v27
    s_lshl_b32 s38, s35, 9
    s_add_u32 s38, s38, 73728
    s_add_u32 s39, s38, s30
    v_add_u32 v53, s39, v57
    s_add_u32 s39, s38, s55
    v_add_u32 v54, s39, v57
    v_lshrrev_b32 v39, 3, v0
    v_and_b32 v40, 6, v39
    v_and_b32 v41, 7, v0
    v_xor_b32 v40, v40, v41
    v_lshlrev_b32 v40, 4, v40
    v_lshl_add_u32 v19, v39, 9, v40
    v_and_b32 v39, 3, v39
    v_lshlrev_b32 v39, 5, v39
    v_lshrrev_b32 v40, 2, v0
    v_and_b32 v41, 3, v0
    v_lshlrev_b32 v41, 3, v41
    v_lshl_add_u32 v41, v40, 7, v41
    v_add_u32 v41, s30, v41
    v_xor_b32 v40, 0, v39
    v_add_u32 v9, v40, v41
    v_xor_b32 v40, 32, v39
    v_add_u32 v10, v40, v41
    v_xor_b32 v40, 64, v39
    v_add_u32 v11, v40, v41
    v_xor_b32 v40, 96, v39
    v_add_u32 v12, v40, v41
    v_mov_b32 v20, 0x3f803f80
    v_mov_b32 v21, 0x3f803f80
    v_mov_b32 v22, 0x3f803f80
    v_mov_b32 v23, 0x3f803f80
    s_waitcnt vmcnt(4)
    s_barrier
    ds_read_b128 a[0:3], v35 offset:0
    ds_read_b128 a[32:35], v35 offset:8192
    ds_read_b128 a[64:67], v35 offset:16384
    ds_read_b128 a[204:207], v5 offset:0
    ds_read_b128 a[4:7], v36 offset:0
    ds_read_b128 a[36:39], v36 offset:8192
    ds_read_b128 a[68:71], v36 offset:16384
    ds_read_b128 a[208:211], v6 offset:0
    s_add_u32 m0, s29, 16384
    s_add_u32 s31, s28, 32768
    buffer_load_dwordx4 v1, s[16:19], s31 offen nt lds
    ds_read_b128 a[8:11], v37 offset:0
    ds_read_b128 a[40:43], v37 offset:8192
    ds_read_b128 a[72:75], v37 offset:16384
    ds_read_b128 a[212:215], v7 offset:0
    ds_read_b128 a[12:15], v38 offset:0
    ds_read_b128 a[44:47], v38 offset:8192
    ds_read_b128 a[76:79], v38 offset:16384
    ds_read_b128 a[216:219], v8 offset:0
    buffer_load_dwordx4 v2, s[16:19], s31 offen offset:1024 nt lds
    ds_read_b128 a[16:19], v35 offset:256
    ds_read_b128 a[48:51], v35 offset:8448
    ds_read_b128 a[80:83], v35 offset:16640
    ds_read_b128 a[220:223], v5 offset:256
    ds_read_b128 a[20:23], v36 offset:256
    ds_read_b128 a[52:55], v36 offset:8448
    ds_read_b128 a[84:87], v36 offset:16640
    ds_read_b128 a[224:227], v6 offset:256
    buffer_load_dwordx4 v3, s[16:19], s31 offen offset:2048 nt lds
    ds_read_b128 a[24:27], v37 offset:256
    ds_read_b128 a[56:59], v37 offset:8448
    ds_read_b128 a[88:91], v37 offset:16640
    ds_read_b128 a[28:31], v38 offset:256
    ds_read_b128 a[60:63], v38 offset:8448
    ds_read_b128 a[92:95], v38 offset:16640
    buffer_load_dwordx4 v4, s[16:19], s31 offen offset:3072 nt lds
    s_waitcnt lgkmcnt(0)
L_s0:
    v_mfma_f32_16x16x32_bf16 v[64:67], a[204:207], a[0:3], 0
    ds_read_b128 a[228:231], v7 offset:256
    v_mfma_f32_16x16x32_bf16 v[68:71], a[204:207], a[32:35], 0
    v_mfma_f32_16x16x32_bf16 v[72:75], a[204:207], a[64:67], 0
    s_waitcnt lgkmcnt(15)
L_s1:
    v_mfma_f32_16x16x32_bf16 v[64:67], a[208:211], a[4:7], v[64:67]
    ds_read_b128 a[204:207], v8 offset:256
    v_mfma_f32_16x16x32_bf16 v[68:71], a[208:211], a[36:39], v[68:71]
    v_mfma_f32_16x16x32_bf16 v[72:75], a[208:211], a[68:71], v[72:75]
    s_waitcnt lgkmcnt(15)
L_s2:
    v_mfma_f32_16x16x32_bf16 v[64:67], a[212:215], a[8:11], v[64:67]
    s_waitcnt vmcnt(4)
    s_barrier
    s_add_u32 m0, s29, 24576
    ds_read_b128 a[208:211], v5 offset:8192
    v_mfma_f32_16x16x32_bf16 v[68:71], a[212:215], a[40:43], v[68:71]
    s_add_u32 s31, s28, 49152
    v_mfma_f32_16x16x32_bf16 v[72:75], a[212:215], a[72:75], v[72:75]
    s_waitcnt lgkmcnt(15)
L_s3:
    v_mfma_f32_16x16x32_bf16 v[64:67], a[216:219], a[12:15], v[64:67]
    ds_read_b128 a[212:215], v6 offset:8192
    v_mfma_f32_16x16x32_bf16 v[68:71], a[216:219], a[44:47], v[68:71]
    buffer_load_dwordx4 v1, s[16:19], s31 offen nt lds
    v_mfma_f32_16x16x32_bf16 v[72:75], a[216:219], a[76:79], v[72:75]
    s_waitcnt lgkmcnt(14)
L_s4:
    v_mfma_f32_16x16x32_bf16 v[64:67], a[220:223], a[16:19], v[64:67]
    ds_read_b128 a[216:219], v7 offset:8192
    v_mfma_f32_16x16x32_bf16 v[68:71], a[220:223], a[48:51], v[68:71]
    v_mfma_f32_16x16x32_bf16 v[72:75], a[220:223], a[80:83], v[72:75]
    s_waitcnt lgkmcnt(11)
L_s5:
    v_mfma_f32_16x16x32_bf16 v[64:67], a[224:227], a[20:23], v[64:67]
    ds_read_b128 a[220:223], v8 offset:8192
    v_mfma_f32_16x16x32_bf16 v[68:71], a[224:227], a[52:55], v[68:71]
    buffer_load_dwordx4 v2, s[16:19], s31 offen offset:1024 nt lds
    v_mfma_f32_16x16x32_bf16 v[72:75], a[224:227], a[84:87], v[72:75]
    s_waitcnt lgkmcnt(5)
L_s6:
    v_mfma_f32_16x16x32_bf16 v[64:67], a[228:231], a[24:27], v[64:67]
    ds_read_b128 a[224:227], v5 offset:8448
    v_mfma_f32_16x16x32_bf16 v[68:71], a[228:231], a[56:59], v[68:71]
    v_mfma_f32_16x16x32_bf16 v[72:75], a[228:231], a[88:91], v[72:75]
    s_waitcnt lgkmcnt(5)
L_s7:
    v_mfma_f32_16x16x32_bf16 v[64:67], a[204:207], a[28:31], v[64:67]
    ds_read_b128 a[228:231], v6 offset:8448
    v_mfma_f32_16x16x32_bf16 v[68:71], a[204:207], a[60:63], v[68:71]
    buffer_load_dwordx4 v3, s[16:19], s31 offen offset:2048 nt lds
    v_mfma_f32_16x16x32_bf16 v[72:75], a[204:207], a[92:95], v[72:75]
    s_waitcnt lgkmcnt(5)
L_s8:
    v_mfma_f32_16x16x32_bf16 v[76:79], a[208:211], a[0:3], 0
    ds_read_b128 a[204:207], v7 offset:8448
    v_mfma_f32_16x16x32_bf16 v[80:83], a[208:211], a[32:35], 0
    v_max3_f32 v13, s44, v64, v65
    v_max3_f32 v13, v13, v66, v67
    v_mfma_f32_16x16x32_bf16 v[84:87], a[208:211], a[64:67], 0
    s_waitcnt lgkmcnt(5)
    v_max3_f32 v14, s44, v68, v69
    v_max3_f32 v14, v14, v70, v71
L_s9:
    v_mfma_f32_16x16x32_bf16 v[76:79], a[212:215], a[4:7], v[76:79]
    ds_read_b128 a[208:211], v8 offset:8448
    v_max3_f32 v15, s44, v72, v73
    v_mfma_f32_16x16x32_bf16 v[80:83], a[212:215], a[36:39], v[80:83]
    buffer_load_dwordx4 v4, s[16:19], s31 offen offset:3072 nt lds
    v_mfma_f32_16x16x32_bf16 v[84:87], a[212:215], a[68:71], v[84:87]
    s_waitcnt lgkmcnt(5)
    v_max3_f32 v15, v15, v74, v75
L_s10:
    v_mfma_f32_16x16x32_bf16 v[76:79], a[216:219], a[8:11], v[76:79]
    s_waitcnt vmcnt(4)
    s_barrier
    s_add_u32 m0, s29, 32768
    ds_read_b128 a[212:215], v5 offset:16384
    v_mfma_f32_16x16x32_bf16 v[80:83], a[216:219], a[40:43], v[80:83]
    s_add_u32 s31, s28, 65536
    v_mfma_f32_16x16x32_bf16 v[84:87], a[216:219], a[72:75], v[84:87]
    s_waitcnt lgkmcnt(5)
L_s11:
    v_mfma_f32_16x16x32_bf16 v[76:79], a[220:223], a[12:15], v[76:79]
    ds_read_b128 a[216:219], v6 offset:16384
    v_mfma_f32_16x16x32_bf16 v[80:83], a[220:223], a[44:47], v[80:83]
    buffer_load_dwordx4 v1, s[16:19], s31 offen nt lds
    v_mfma_f32_16x16x32_bf16 v[84:87], a[220:223], a[76:79], v[84:87]
    s_waitcnt lgkmcnt(5)
L_s12:
    v_mfma_f32_16x16x32_bf16 v[76:79], a[224:227], a[16:19], v[76:79]
    ds_read_b128 a[220:223], v7 offset:16384
    v_mfma_f32_16x16x32_bf16 v[80:83], a[224:227], a[48:51], v[80:83]
    v_mfma_f32_16x16x32_bf16 v[84:87], a[224:227], a[80:83], v[84:87]
    s_waitcnt lgkmcnt(5)
L_s13:
    v_mfma_f32_16x16x32_bf16 v[76:79], a[228:231], a[20:23], v[76:79]
    ds_read_b128 a[224:227], v8 offset:16384
    v_mfma_f32_16x16x32_bf16 v[80:83], a[228:231], a[52:55], v[80:83]
    buffer_load_dwordx4 v2, s[16:19], s31 offen offset:1024 nt lds
    v_mfma_f32_16x16x32_bf16 v[84:87], a[228:231], a[84:87], v[84:87]
    s_waitcnt lgkmcnt(5)
L_s14:
    v_mfma_f32_16x16x32_bf16 v[76:79], a[204:207], a[24:27], v[76:79]
    ds_read_b128 a[228:231], v5 offset:16640
    v_mfma_f32_16x16x32_bf16 v[80:83], a[204:207], a[56:59], v[80:83]
    v_mfma_f32_16x16x32_bf16 v[84:87], a[204:207], a[88:91], v[84:87]
    s_waitcnt lgkmcnt(5)
L_s15:
    v_mfma_f32_16x16x32_bf16 v[76:79], a[208:211], a[28:31], v[76:79]
    ds_read_b128 a[204:207], v6 offset:16640
    v_mfma_f32_16x16x32_bf16 v[80:83], a[208:211], a[60:63], v[80:83]
    buffer_load_dwordx4 v3, s[16:19], s31 offen offset:2048 nt lds
    v_mfma_f32_16x16x32_bf16 v[84:87], a[208:211], a[92:95], v[84:87]
    s_waitcnt lgkmcnt(5)
L_s16:
    v_mfma_f32_16x16x32_bf16 v[88:91], a[212:215], a[0:3], 0
    ds_read_b128 a[208:211], v7 offset:16640
    v_mfma_f32_16x16x32_bf16 v[92:95], a[212:215], a[32:35], 0
    v_max3_f32 v13, v13, v76, v77
    v_max3_f32 v13, v13, v78, v79
    v_mfma_f32_16x16x32_bf16 v[96:99], a[212:215], a[64:67], 0
    s_waitcnt lgkmcnt(5)
    v_max3_f32 v14, v14, v80, v81
    v_max3_f32 v14, v14, v82, v83
L_s17:
    v_mfma_f32_16x16x32_bf16 v[88:91], a[216:219], a[4:7], v[88:91]
    ds_read_b128 a[212:215], v8 offset:16640
    v_max3_f32 v15, v15, v84, v85
    v_mfma_f32_16x16x32_bf16 v[92:95], a[216:219], a[36:39], v[92:95]
    buffer_load_dwordx4 v4, s[16:19], s31 offen offset:3072 nt lds
    v_mfma_f32_16x16x32_bf16 v[96:99], a[216:219], a[68:71], v[96:99]
    s_waitcnt lgkmcnt(5)
    v_max3_f32 v15, v15, v86, v87
L_s18:
    v_mfma_f32_16x16x32_bf16 v[88:91], a[220:223], a[8:11], v[88:91]
    s_waitcnt vmcnt(4)
    s_barrier
    s_add_u32 m0, s29, 40960
    ds_read_b128 a[216:219], v5 offset:24576
    v_mfma_f32_16x16x32_bf16 v[92:95], a[220:223], a[40:43], v[92:95]
    s_add_u32 s31, s28, 81920
    v_mfma_f32_16x16x32_bf16 v[96:99], a[220:223], a[72:75], v[96:99]
    s_waitcnt lgkmcnt(5)
L_s19:
    v_mfma_f32_16x16x32_bf16 v[88:91], a[224:227], a[12:15], v[88:91]
    ds_read_b128 a[220:223], v6 offset:24576
    v_mfma_f32_16x16x32_bf16 v[92:95], a[224:227], a[44:47], v[92:95]
    buffer_load_dwordx4 v1, s[16:19], s31 offen nt lds
    v_mfma_f32_16x16x32_bf16 v[96:99], a[224:227], a[76:79], v[96:99]
    s_waitcnt lgkmcnt(5)
L_s20:
    v_mfma_f32_16x16x32_bf16 v[88:91], a[228:231], a[16:19], v[88:91]
    ds_read_b128 a[224:227], v7 offset:24576
    v_mfma_f32_16x16x32_bf16 v[92:95], a[228:231], a[48:51], v[92:95]
    v_mfma_f32_16x16x32_bf16 v[96:99], a[228:231], a[80:83], v[96:99]
    s_waitcnt lgkmcnt(5)
L_s21:
    v_mfma_f32_16x16x32_bf16 v[88:91], a[204:207], a[20:23], v[88:91]
    ds_read_b128 a[228:231], v8 offset:24576
    v_mfma_f32_16x16x32_bf16 v[92:95], a[204:207], a[52:55], v[92:95]
    buffer_load_dwordx4 v2, s[16:19], s31 offen offset:1024 nt lds
    v_mfma_f32_16x16x32_bf16 v[96:99], a[204:207], a[84:87], v[96:99]
    s_waitcnt lgkmcnt(5)
L_s22:
    v_mfma_f32_16x16x32_bf16 v[88:91], a[208:211], a[24:27], v[88:91]
    ds_read_b128 a[204:207], v5 offset:24832
    v_mfma_f32_16x16x32_bf16 v[92:95], a[208:211], a[56:59], v[92:95]
    v_mfma_f32_16x16x32_bf16 v[96:99], a[208:211], a[88:91], v[96:99]
    s_waitcnt lgkmcnt(5)
L_s23:
    v_mfma_f32_16x16x32_bf16 v[88:91], a[212:215], a[28:31], v[88:91]
    ds_read_b128 a[208:211], v6 offset:24832
    v_mfma_f32_16x16x32_bf16 v[92:95], a[212:215], a[60:63], v[92:95]
    buffer_load_dwordx4 v3, s[16:19], s31 offen offset:2048 nt lds
    v_mfma_f32_16x16x32_bf16 v[96:99], a[212:215], a[92:95], v[96:99]
    s_waitcnt lgkmcnt(5)
L_s24:
    v_mfma_f32_16x16x32_bf16 v[100:103], a[216:219], a[0:3], 0
    ds_read_b128 a[212:215], v7 offset:24832
    v_mfma_f32_16x16x32_bf16 v[104:107], a[216:219], a[32:35], 0
    v_max3_f32 v13, v13, v88, v89
    v_max3_f32 v13, v13, v90, v91
    v_mfma_f32_16x16x32_bf16 v[108:111], a[216:219], a[64:67], 0
    s_waitcnt lgkmcnt(5)
    v_max3_f32 v14, v14, v92, v93
    v_max3_f32 v14, v14, v94, v95
L_s25:
    v_mfma_f32_16x16x32_bf16 v[100:103], a[220:223], a[4:7], v[100:103]
    ds_read_b128 a[216:219], v8 offset:24832
    v_max3_f32 v15, v15, v96, v97
    v_mfma_f32_16x16x32_bf16 v[104:107], a[220:223], a[36:39], v[104:107]
    buffer_load_dwordx4 v4, s[16:19], s31 offen offset:3072 nt lds
    v_mfma_f32_16x16x32_bf16 v[108:111], a[220:223], a[68:71], v[108:111]
    s_waitcnt lgkmcnt(5)
    v_max3_f32 v15, v15, v98, v99
L_s26:
    v_mfma_f32_16x16x32_bf16 v[100:103], a[224:227], a[8:11], v[100:103]
    s_waitcnt vmcnt(4)
    s_barrier
    s_add_u32 m0, s29, 0
    ds_read_b128 a[220:223], v5 offset:32768
    v_mfma_f32_16x16x32_bf16 v[104:107], a[224:227], a[40:43], v[104:107]
    s_add_u32 s31, s28, 98304
    v_mfma_f32_16x16x32_bf16 v[108:111], a[224:227], a[72:75], v[108:111]
    s_waitcnt lgkmcnt(5)
L_s27:
    v_mfma_f32_16x16x32_bf16 v[100:103], a[228:231], a[12:15], v[100:103]
    ds_read_b128 a[224:227], v6 offset:32768
    v_mfma_f32_16x16x32_bf16 v[104:107], a[228:231], a[44:47], v[104:107]
    buffer_load_dwordx4 v1, s[16:19], s31 offen nt lds
    v_mfma_f32_16x16x32_bf16 v[108:111], a[228:231], a[76:79], v[108:111]
    s_waitcnt lgkmcnt(5)
L_s28:
    v_mfma_f32_16x16x32_bf16 v[100:103], a[204:207], a[16:19], v[100:103]
    ds_read_b128 a[228:231], v7 offset:32768
    v_mfma_f32_16x16x32_bf16 v[104:107], a[204:207], a[48:51], v[104:107]
    v_mfma_f32_16x16x32_bf16 v[108:111], a[204:207], a[80:83], v[108:111]
    s_waitcnt lgkmcnt(5)
L_s29:
    v_mfma_f32_16x16x32_bf16 v[100:103], a[208:211], a[20:23], v[100:103]
    ds_read_b128 a[204:207], v8 offset:32768
    v_mfma_f32_16x16x32_bf16 v[104:107], a[208:211], a[52:55], v[104:107]
    buffer_load_dwordx4 v2, s[16:19], s31 offen offset:1024 nt lds
    v_mfma_f32_16x16x32_bf16 v[108:111], a[208:211], a[84:87], v[108:111]
    s_waitcnt lgkmcnt(5)
L_s30:
    v_mfma_f32_16x16x32_bf16 v[100:103], a[212:215], a[24:27], v[100:103]
    ds_read_b128 a[208:211], v5 offset:33024
    v_mfma_f32_16x16x32_bf16 v[104:107], a[212:215], a[56:59], v[104:107]
    v_mfma_f32_16x16x32_bf16 v[108:111], a[212:215], a[88:91], v[108:111]
    s_waitcnt lgkmcnt(5)
L_s31:
    v_mfma_f32_16x16x32_bf16 v[100:103], a[216:219], a[28:31], v[100:103]
    ds_read_b128 a[212:215], v6 offset:33024
    v_mfma_f32_16x16x32_bf16 v[104:107], a[216:219], a[60:63], v[104:107]
    buffer_load_dwordx4 v3, s[16:19], s31 offen offset:2048 nt lds
    v_mfma_f32_16x16x32_bf16 v[108:111], a[216:219], a[92:95], v[108:111]
    s_waitcnt lgkmcnt(5)
L_s32:
    v_mfma_f32_16x16x32_bf16 v[112:115], a[220:223], a[0:3], 0
    ds_read_b128 a[216:219], v7 offset:33024
    v_mfma_f32_16x16x32_bf16 v[116:119], a[220:223], a[32:35], 0
    v_max3_f32 v13, v13, v100, v101
    v_max3_f32 v13, v13, v102, v103
    v_mfma_f32_16x16x32_bf16 v[120:123], a[220:223], a[64:67], 0
    s_waitcnt lgkmcnt(5)
    v_max3_f32 v14, v14, v104, v105
    v_max3_f32 v14, v14, v106, v107
L_s33:
    v_mfma_f32_16x16x32_bf16 v[112:115], a[224:227], a[4:7], v[112:115]
    ds_read_b128 a[220:223], v8 offset:33024
    v_max3_f32 v15, v15, v108, v109
    v_mfma_f32_16x16x32_bf16 v[116:119], a[224:227], a[36:39], v[116:119]
    buffer_load_dwordx4 v4, s[16:19], s31 offen offset:3072 nt lds
    v_mfma_f32_16x16x32_bf16 v[120:123], a[224:227], a[68:71], v[120:123]
    s_waitcnt lgkmcnt(5)
    v_max3_f32 v15, v15, v110, v111
L_s34:
    v_mfma_f32_16x16x32_bf16 v[112:115], a[228:231], a[8:11], v[112:115]
    s_waitcnt vmcnt(4)
    s_barrier
    s_add_u32 m0, s29, 8192
    ds_read_b128 a[224:227], v5 offset:40960
    v_mfma_f32_16x16x32_bf16 v[116:119], a[228:231], a[40:43], v[116:119]
    s_add_u32 s31, s28, 114688
    v_mfma_f32_16x16x32_bf16 v[120:123], a[228:231], a[72:75], v[120:123]
    s_waitcnt lgkmcnt(5)
L_s35:
    v_mfma_f32_16x16x32_bf16 v[112:115], a[204:207], a[12:15], v[112:115]
    ds_read_b128 a[228:231], v6 offset:40960
    v_mfma_f32_16x16x32_bf16 v[116:119], a[204:207], a[44:47], v[116:119]
    buffer_load_dwordx4 v1, s[16:19], s31 offen nt lds
    v_mfma_f32_16x16x32_bf16 v[120:123], a[204:207], a[76:79], v[120:123]
    s_waitcnt lgkmcnt(5)
L_s36:
    v_mfma_f32_16x16x32_bf16 v[112:115], a[208:211], a[16:19], v[112:115]
    ds_read_b128 a[204:207], v7 offset:40960
    v_mfma_f32_16x16x32_bf16 v[116:119], a[208:211], a[48:51], v[116:119]
    v_mfma_f32_16x16x32_bf16 v[120:123], a[208:211], a[80:83], v[120:123]
    s_waitcnt lgkmcnt(5)
L_s37:
    v_mfma_f32_16x16x32_bf16 v[112:115], a[212:215], a[20:23], v[112:115]
    ds_read_b128 a[208:211], v8 offset:40960
    v_mfma_f32_16x16x32_bf16 v[116:119], a[212:215], a[52:55], v[116:119]
    buffer_load_dwordx4 v2, s[16:19], s31 offen offset:1024 nt lds
    v_mfma_f32_16x16x32_bf16 v[120:123], a[212:215], a[84:87], v[120:123]
    s_waitcnt lgkmcnt(5)
L_s38:
    v_mfma_f32_16x16x32_bf16 v[112:115], a[216:219], a[24:27], v[112:115]
    ds_read_b128 a[212:215], v5 offset:41216
    v_mfma_f32_16x16x32_bf16 v[116:119], a[216:219], a[56:59], v[116:119]
    v_mfma_f32_16x16x32_bf16 v[120:123], a[216:219], a[88:91], v[120:123]
    s_waitcnt lgkmcnt(5)
L_s39:
    v_mfma_f32_16x16x32_bf16 v[112:115], a[220:223], a[28:31], v[112:115]
    ds_read_b128 a[216:219], v6 offset:41216
    v_mfma_f32_16x16x32_bf16 v[116:119], a[220:223], a[60:63], v[116:119]
    buffer_load_dwordx4 v3, s[16:19], s31 offen offset:2048 nt lds
    v_mfma_f32_16x16x32_bf16 v[120:123], a[220:223], a[92:95], v[120:123]
    s_waitcnt lgkmcnt(5)
L_s40:
    v_mfma_f32_16x16x32_bf16 v[124:127], a[224:227], a[0:3], 0
    ds_read_b128 a[220:223], v7 offset:41216
    v_mfma_f32_16x16x32_bf16 v[128:131], a[224:227], a[32:35], 0
    v_max3_f32 v13, v13, v112, v113
    v_max3_f32 v13, v13, v114, v115
    v_mfma_f32_16x16x32_bf16 v[132:135], a[224:227], a[64:67], 0
    s_waitcnt lgkmcnt(5)
    v_max3_f32 v14, v14, v116, v117
    v_max3_f32 v14, v14, v118, v119
L_s41:
    v_mfma_f32_16x16x32_bf16 v[124:127], a[228:231], a[4:7], v[124:127]
    ds_read_b128 a[224:227], v8 offset:41216
    v_max3_f32 v15, v15, v120, v121
    v_mfma_f32_16x16x32_bf16 v[128:131], a[228:231], a[36:39], v[128:131]
    buffer_load_dwordx4 v4, s[16:19], s31 offen offset:3072 nt lds
    v_mfma_f32_16x16x32_bf16 v[132:135], a[228:231], a[68:71], v[132:135]
    s_waitcnt lgkmcnt(5)
    v_max3_f32 v15, v15, v122, v123
L_s42:
    v_mfma_f32_16x16x32_bf16 v[124:127], a[204:207], a[8:11], v[124:127]
    s_waitcnt vmcnt(4)
    s_barrier
    s_add_u32 m0, s29, 16384
    ds_read_b128 a[228:231], v5 offset:0
    v_mfma_f32_16x16x32_bf16 v[128:131], a[204:207], a[40:43], v[128:131]
    s_add_u32 s31, s28, 131072
    v_mfma_f32_16x16x32_bf16 v[132:135], a[204:207], a[72:75], v[132:135]
    s_waitcnt lgkmcnt(5)
L_s43:
    v_mfma_f32_16x16x32_bf16 v[124:127], a[208:211], a[12:15], v[124:127]
    ds_read_b128 a[204:207], v6 offset:0
    v_mfma_f32_16x16x32_bf16 v[128:131], a[208:211], a[44:47], v[128:131]
    buffer_load_dwordx4 v1, s[16:19], s31 offen nt lds
    v_mfma_f32_16x16x32_bf16 v[132:135], a[208:211], a[76:79], v[132:135]
    s_waitcnt lgkmcnt(5)
L_s44:
    v_mfma_f32_16x16x32_bf16 v[124:127], a[212:215], a[16:19], v[124:127]
    ds_read_b128 a[208:211], v7 offset:0
    v_mfma_f32_16x16x32_bf16 v[128:131], a[212:215], a[48:51], v[128:131]
    buffer_load_dwordx4 v2, s[16:19], s31 offen offset:1024 nt lds
    v_mfma_f32_16x16x32_bf16 v[132:135], a[212:215], a[80:83], v[132:135]
    s_waitcnt lgkmcnt(5)
L_s45:
    v_mfma_f32_16x16x32_bf16 v[124:127], a[216:219], a[20:23], v[124:127]
    ds_read_b128 a[212:215], v8 offset:0
    v_mfma_f32_16x16x32_bf16 v[128:131], a[216:219], a[52:55], v[128:131]
    buffer_load_dwordx4 v3, s[16:19], s31 offen offset:2048 nt lds
    v_mfma_f32_16x16x32_bf16 v[132:135], a[216:219], a[84:87], v[132:135]
    s_waitcnt lgkmcnt(5)
L_s46:
    v_mfma_f32_16x16x32_bf16 v[124:127], a[220:223], a[24:27], v[124:127]
    ds_read_b128 a[216:219], v5 offset:256
    v_mfma_f32_16x16x32_bf16 v[128:131], a[220:223], a[56:59], v[128:131]
    buffer_load_dwordx4 v4, s[16:19], s31 offen offset:3072 nt lds
    v_mfma_f32_16x16x32_bf16 v[132:135], a[220:223], a[88:91], v[132:135]
    s_waitcnt lgkmcnt(5)
L_s47:
    v_mfma_f32_16x16x32_bf16 v[124:127], a[224:227], a[28:31], v[124:127]
    s_add_u32 m0, s29, 24576
    s_add_u32 s31, s28, 147456
    ds_read_b128 a[220:223], v6 offset:256
    v_mfma_f32_16x16x32_bf16 v[128:131], a[224:227], a[60:63], v[128:131]
    buffer_load_dwordx4 v1, s[16:19], s31 offen nt lds
    v_mfma_f32_16x16x32_bf16 v[132:135], a[224:227], a[92:95], v[132:135]
    s_waitcnt lgkmcnt(5)
L_s48:
    v_mfma_f32_16x16x32_bf16 v[136:139], a[228:231], a[0:3], 0
    ds_read_b128 a[224:227], v7 offset:256
    v_max3_f32 v13, v13, v124, v125
    v_mfma_f32_16x16x32_bf16 v[140:143], a[228:231], a[32:35], 0
    buffer_load_dwordx4 v2, s[16:19], s31 offen offset:1024 nt lds
    v_mfma_f32_16x16x32_bf16 v[144:147], a[228:231], a[64:67], 0
    s_waitcnt lgkmcnt(5)
    v_max3_f32 v13, v13, v126, v127
    v_max3_f32 v14, v14, v128, v129
L_s49:
    v_mfma_f32_16x16x32_bf16 v[136:139], a[204:207], a[4:7], v[136:139]
    ds_read_b128 a[228:231], v8 offset:256
    v_max3_f32 v14, v14, v130, v131
    v_mfma_f32_16x16x32_bf16 v[140:143], a[204:207], a[36:39], v[140:143]
    buffer_load_dwordx4 v3, s[16:19], s31 offen offset:2048 nt lds
    v_mfma_f32_16x16x32_bf16 v[144:147], a[204:207], a[68:71], v[144:147]
    s_waitcnt lgkmcnt(5)
    v_max3_f32 v15, v15, v132, v133
    v_max3_f32 v15, v15, v134, v135
L_s50:
    v_mfma_f32_16x16x32_bf16 v[136:139], a[208:211], a[8:11], v[136:139]
    s_waitcnt vmcnt(7)
    s_barrier
    ds_read_b128 a[204:207], v5 offset:8192
    v_mfma_f32_16x16x32_bf16 v[140:143], a[208:211], a[40:43], v[140:143]
    v_mfma_f32_16x16x32_bf16 v[144:147], a[208:211], a[72:75], v[144:147]
    s_waitcnt lgkmcnt(5)
L_s51:
    v_mfma_f32_16x16x32_bf16 v[136:139], a[212:215], a[12:15], v[136:139]
    ds_read_b128 a[208:211], v6 offset:8192
    v_mfma_f32_16x16x32_bf16 v[140:143], a[212:215], a[44:47], v[140:143]
    buffer_load_dwordx4 v4, s[16:19], s31 offen offset:3072 nt lds
    v_mfma_f32_16x16x32_bf16 v[144:147], a[212:215], a[76:79], v[144:147]
    s_waitcnt lgkmcnt(5)
L_s52:
    v_mfma_f32_16x16x32_bf16 v[136:139], a[216:219], a[16:19], v[136:139]
    s_add_u32 m0, s29, 32768
    s_add_u32 s31, s28, 163840
    ds_read_b128 a[212:215], v7 offset:8192
    v_mfma_f32_16x16x32_bf16 v[140:143], a[216:219], a[48:51], v[140:143]
    buffer_load_dwordx4 v1, s[16:19], s31 offen nt lds
    v_mfma_f32_16x16x32_bf16 v[144:147], a[216:219], a[80:83], v[144:147]
    s_waitcnt lgkmcnt(5)
L_s53:
    v_mfma_f32_16x16x32_bf16 v[136:139], a[220:223], a[20:23], v[136:139]
    ds_read_b128 a[216:219], v8 offset:8192
    v_mfma_f32_16x16x32_bf16 v[140:143], a[220:223], a[52:55], v[140:143]
    buffer_load_dwordx4 v2, s[16:19], s31 offen offset:1024 nt lds
    v_mfma_f32_16x16x32_bf16 v[144:147], a[220:223], a[84:87], v[144:147]
    s_waitcnt lgkmcnt(5)
L_s54:
    v_mfma_f32_16x16x32_bf16 v[136:139], a[224:227], a[24:27], v[136:139]
    ds_read_b128 a[220:223], v5 offset:8448
    v_mfma_f32_16x16x32_bf16 v[140:143], a[224:227], a[56:59], v[140:143]
    v_mfma_f32_16x16x32_bf16 v[144:147], a[224:227], a[88:91], v[144:147]
    s_waitcnt lgkmcnt(5)
L_s55:
    v_mfma_f32_16x16x32_bf16 v[136:139], a[228:231], a[28:31], v[136:139]
    ds_read_b128 a[224:227], v6 offset:8448
    v_mfma_f32_16x16x32_bf16 v[140:143], a[228:231], a[60:63], v[140:143]
    buffer_load_dwordx4 v3, s[16:19], s31 offen offset:2048 nt lds
    v_mfma_f32_16x16x32_bf16 v[144:147], a[228:231], a[92:95], v[144:147]
    s_waitcnt lgkmcnt(5)
L_s56:
    v_mfma_f32_16x16x32_bf16 v[148:151], a[204:207], a[0:3], 0
    ds_read_b128 a[228:231], v7 offset:8448
    v_mfma_f32_16x16x32_bf16 v[152:155], a[204:207], a[32:35], 0
    v_max3_f32 v13, v13, v136, v137
    v_max3_f32 v13, v13, v138, v139
    v_mfma_f32_16x16x32_bf16 v[156:159], a[204:207], a[64:67], 0
    s_waitcnt lgkmcnt(5)
    v_max3_f32 v14, v14, v140, v141
    v_max3_f32 v14, v14, v142, v143
L_s57:
    v_mfma_f32_16x16x32_bf16 v[148:151], a[208:211], a[4:7], v[148:151]
    ds_read_b128 a[204:207], v8 offset:8448
    v_max3_f32 v15, v15, v144, v145
    v_mfma_f32_16x16x32_bf16 v[152:155], a[208:211], a[36:39], v[152:155]
    buffer_load_dwordx4 v4, s[16:19], s31 offen offset:3072 nt lds
    v_mfma_f32_16x16x32_bf16 v[156:159], a[208:211], a[68:71], v[156:159]
    s_waitcnt lgkmcnt(5)
    v_max3_f32 v15, v15, v146, v147
L_s58:
    v_mfma_f32_16x16x32_bf16 v[148:151], a[212:215], a[8:11], v[148:151]
    s_waitcnt vmcnt(8)
    s_barrier
    s_add_u32 m0, s29, 40960
    ds_read_b128 a[208:211], v5 offset:16384
    v_mfma_f32_16x16x32_bf16 v[152:155], a[212:215], a[40:43], v[152:155]
    s_add_u32 s31, s28, 180224
    v_mfma_f32_16x16x32_bf16 v[156:159], a[212:215], a[72:75], v[156:159]
    s_waitcnt lgkmcnt(5)
L_s59:
    v_mfma_f32_16x16x32_bf16 v[148:151], a[216:219], a[12:15], v[148:151]
    ds_read_b128 a[212:215], v6 offset:16384
    v_mfma_f32_16x16x32_bf16 v[152:155], a[216:219], a[44:47], v[152:155]
    buffer_load_dwordx4 v1, s[16:19], s31 offen nt lds
    v_mfma_f32_16x16x32_bf16 v[156:159], a[216:219], a[76:79], v[156:159]
    s_waitcnt lgkmcnt(5)
L_s60:
    v_mfma_f32_16x16x32_bf16 v[148:151], a[220:223], a[16:19], v[148:151]
    ds_read_b128 a[216:219], v7 offset:16384
    v_mfma_f32_16x16x32_bf16 v[152:155], a[220:223], a[48:51], v[152:155]
    v_mfma_f32_16x16x32_bf16 v[156:159], a[220:223], a[80:83], v[156:159]
    s_waitcnt lgkmcnt(5)
L_s61:
    v_mfma_f32_16x16x32_bf16 v[148:151], a[224:227], a[20:23], v[148:151]
    ds_read_b128 a[220:223], v8 offset:16384
    v_mfma_f32_16x16x32_bf16 v[152:155], a[224:227], a[52:55], v[152:155]
    buffer_load_dwordx4 v2, s[16:19], s31 offen offset:1024 nt lds
    v_mfma_f32_16x16x32_bf16 v[156:159], a[224:227], a[84:87], v[156:159]
    s_waitcnt lgkmcnt(5)
L_s62:
    v_mfma_f32_16x16x32_bf16 v[148:151], a[228:231], a[24:27], v[148:151]
    ds_read_b128 a[224:227], v5 offset:16640
    v_mfma_f32_16x16x32_bf16 v[152:155], a[228:231], a[56:59], v[152:155]
    v_mfma_f32_16x16x32_bf16 v[156:159], a[228:231], a[88:91], v[156:159]
    s_waitcnt lgkmcnt(5)
L_s63:
    v_mfma_f32_16x16x32_bf16 v[148:151], a[204:207], a[28:31], v[148:151]
    ds_read_b128 a[228:231], v6 offset:16640
    v_mfma_f32_16x16x32_bf16 v[152:155], a[204:207], a[60:63], v[152:155]
    buffer_load_dwordx4 v3, s[16:19], s31 offen offset:2048 nt lds
    v_mfma_f32_16x16x32_bf16 v[156:159], a[204:207], a[92:95], v[156:159]
    s_waitcnt lgkmcnt(5)
L_s64:
    v_mfma_f32_16x16x32_bf16 v[160:163], a[208:211], a[0:3], 0
    ds_read_b128 a[204:207], v7 offset:16640
    v_mfma_f32_16x16x32_bf16 v[164:167], a[208:211], a[32:35], 0
    v_max3_f32 v13, v13, v148, v149
    v_max3_f32 v13, v13, v150, v151
    v_max3_f32 v14, v14, v152, v153
    v_max3_f32 v14, v14, v154, v155
    v_mfma_f32_16x16x32_bf16 v[168:171], a[208:211], a[64:67], 0
    s_waitcnt lgkmcnt(5)
    v_max3_f32 v15, v15, v156, v157
    v_max3_f32 v15, v15, v158, v159
    v_mov_b32_e32 v32, v13
    v_mov_b32_e64 v33, v13
L_s65:
    v_mfma_f32_16x16x32_bf16 v[160:163], a[212:215], a[4:7], v[160:163]
    ds_read_b128 a[208:211], v8 offset:16640
    v_permlane32_swap_b32 v32, v33
    v_max_f32_e32 v32, v32, v33
    v_mov_b32_e64 v33, v32
    v_mfma_f32_16x16x32_bf16 v[164:167], a[212:215], a[36:39], v[164:167]
    buffer_load_dwordx4 v4, s[16:19], s31 offen offset:3072 nt lds
    v_permlane16_swap_b32 v32, v33
    v_max_f32_e32 v32, v32, v33
    v_mfma_f32_16x16x32_bf16 v[168:171], a[212:215], a[68:71], v[168:171]
    s_waitcnt lgkmcnt(5)
    v_mul_f32_e32 v32, s32, v32
    v_ceil_f32_e64 v16, v32
    v_mov_b32_e64 v34, v14
    v_mov_b32_e64 v35, v14
L_s66:
    v_mfma_f32_16x16x32_bf16 v[160:163], a[216:219], a[8:11], v[160:163]
    s_waitcnt vmcnt(8)
    s_barrier
    s_add_u32 m0, s29, 0
    ds_read_b128 a[212:215], v5 offset:24576
    v_permlane32_swap_b32 v34, v35
    v_max_f32_e64 v34, v34, v35
    v_mfma_f32_16x16x32_bf16 v[164:167], a[216:219], a[40:43], v[164:167]
    s_add_u32 s31, s28, 196608
    v_mov_b32_e64 v35, v34
    v_mov_b32_e64 v36, v15
    v_mov_b32_e32 v37, v15
    v_permlane16_swap_b32 v34, v35
    v_mfma_f32_16x16x32_bf16 v[168:171], a[216:219], a[72:75], v[168:171]
    s_waitcnt lgkmcnt(5)
    v_max_f32_e32 v34, v34, v35
    v_mul_f32_e64 v34, s32, v34
    v_ceil_f32_e32 v17, v34
    v_permlane32_swap_b32 v36, v37
L_s67:
    v_mfma_f32_16x16x32_bf16 v[160:163], a[220:223], a[12:15], v[160:163]
    ds_read_b128 a[216:219], v6 offset:24576
    v_max_f32_e64 v36, v36, v37
    v_mov_b32_e64 v37, v36
    v_fma_f32 v64, v64, s32, -v16
    v_mfma_f32_16x16x32_bf16 v[164:167], a[220:223], a[44:47], v[164:167]
    buffer_load_dwordx4 v1, s[16:19], s31 offen nt lds
    v_permlane16_swap_b32 v36, v37
    v_max_f32_e32 v36, v36, v37
    v_mfma_f32_16x16x32_bf16 v[168:171], a[220:223], a[76:79], v[168:171]
    s_waitcnt lgkmcnt(5)
    v_exp_f32_e32 v64, v64
    v_mul_f32_e64 v36, s32, v36
    v_ceil_f32_e64 v18, v36
L_s68:
    v_mfma_f32_16x16x32_bf16 v[160:163], a[224:227], a[16:19], v[160:163]
    ds_read_b128 a[220:223], v7 offset:24576
    v_fma_f32 v65, v65, s32, -v16
    v_fma_f32 v66, v66, s32, -v16
    v_fma_f32 v67, v67, s32, -v16
    v_mfma_f32_16x16x32_bf16 v[164:167], a[224:227], a[48:51], v[164:167]
    buffer_load_dwordx4 v2, s[16:19], s31 offen offset:1024 nt lds
    v_fma_f32 v76, v76, s32, -v16
    v_fma_f32 v77, v77, s32, -v16
    v_mfma_f32_16x16x32_bf16 v[168:171], a[224:227], a[80:83], v[168:171]
    s_waitcnt lgkmcnt(5)
    v_exp_f32_e32 v65, v65
    v_fma_f32 v78, v78, s32, -v16
    v_fma_f32 v79, v79, s32, -v16
L_s69:
    v_mfma_f32_16x16x32_bf16 v[160:163], a[228:231], a[20:23], v[160:163]
    ds_read_b128 a[224:227], v8 offset:24576
    v_cvt_pk_bf16_f32 v64, v64, v65
    v_fma_f32 v68, v68, s32, -v17
    v_fma_f32 v69, v69, s32, -v17
    v_mfma_f32_16x16x32_bf16 v[164:167], a[228:231], a[52:55], v[164:167]
    buffer_load_dwordx4 v3, s[16:19], s31 offen offset:2048 nt lds
    v_fma_f32 v70, v70, s32, -v17
    v_fma_f32 v71, v71, s32, -v17
    v_mfma_f32_16x16x32_bf16 v[168:171], a[228:231], a[84:87], v[168:171]
    s_waitcnt lgkmcnt(5)
    v_exp_f32_e32 v66, v66
    v_fma_f32 v80, v80, s32, -v17
    v_fma_f32 v81, v81, s32, -v17
L_s70:
    v_mfma_f32_16x16x32_bf16 v[160:163], a[204:207], a[24:27], v[160:163]
    ds_read_b128 a[228:231], v5 offset:24832
    v_fma_f32 v82, v82, s32, -v17
    v_fma_f32 v83, v83, s32, -v17
    v_fma_f32 v72, v72, s32, -v18
    v_mfma_f32_16x16x32_bf16 v[164:167], a[204:207], a[56:59], v[164:167]
    buffer_load_dwordx4 v4, s[16:19], s31 offen offset:3072 nt lds
    v_fma_f32 v73, v73, s32, -v18
    v_fma_f32 v74, v74, s32, -v18
    v_mfma_f32_16x16x32_bf16 v[168:171], a[204:207], a[88:91], v[168:171]
    s_waitcnt lgkmcnt(5)
    v_exp_f32_e32 v67, v67
    v_fma_f32 v75, v75, s32, -v18
    v_cvt_pk_bf16_f32 v65, v66, v67
L_s71:
    v_mfma_f32_16x16x32_bf16 v[160:163], a[208:211], a[28:31], v[160:163]
    s_add_u32 m0, s29, 8192
    s_add_u32 s31, s28, 212992
    ds_read_b128 a[204:207], v6 offset:24832
    v_fma_f32 v84, v84, s32, -v18
    v_mfma_f32_16x16x32_bf16 v[164:167], a[208:211], a[60:63], v[164:167]
    buffer_load_dwordx4 v1, s[16:19], s31 offen nt lds
    v_fma_f32 v85, v85, s32, -v18
    v_fma_f32 v86, v86, s32, -v18
    v_mfma_f32_16x16x32_bf16 v[168:171], a[208:211], a[92:95], v[168:171]
    s_waitcnt lgkmcnt(5)
    v_exp_f32_e32 v76, v76
    v_fma_f32 v87, v87, s32, -v18
L_s72:
    v_mfma_f32_16x16x32_bf16 v[172:175], a[212:215], a[0:3], 0
    ds_read_b128 a[208:211], v7 offset:24832
    v_max3_f32 v13, v13, v160, v161
    v_max3_f32 v13, v13, v162, v163
    v_mfma_f32_16x16x32_bf16 v[176:179], a[212:215], a[32:35], 0
    buffer_load_dwordx4 v2, s[16:19], s31 offen offset:1024 nt lds
    v_max3_f32 v14, v14, v164, v165
    v_max3_f32 v14, v14, v166, v167
    v_mfma_f32_16x16x32_bf16 v[180:183], a[212:215], a[64:67], 0
    s_waitcnt lgkmcnt(5)
    v_exp_f32_e32 v77, v77
    v_max3_f32 v15, v15, v168, v169
    v_cvt_pk_bf16_f32 v66, v76, v77
L_s73:
    v_mfma_f32_16x16x32_bf16 v[172:175], a[216:219], a[4:7], v[172:175]
    ds_read_b128 a[212:215], v8 offset:24832
    v_max3_f32 v15, v15, v170, v171
    v_exp_f32_e64 v78, v78
    v_mfma_f32_16x16x32_bf16 v[176:179], a[216:219], a[36:39], v[176:179]
    buffer_load_dwordx4 v3, s[16:19], s31 offen offset:2048 nt lds
    v_exp_f32_e64 v79, v79
    v_mfma_f32_16x16x32_bf16 v[180:183], a[216:219], a[68:71], v[180:183]
    s_waitcnt lgkmcnt(5)
    v_exp_f32_e32 v68, v68
    v_cvt_pk_bf16_f32 v67, v78, v79
L_s74:
    v_mfma_f32_16x16x32_bf16 v[172:175], a[220:223], a[8:11], v[172:175]
    s_waitcnt vmcnt(11)
    s_barrier
    ds_read_b128 a[216:219], v5 offset:32768
    v_exp_f32_e64 v69, v69
    v_mfma_f32_16x16x32_bf16 v[176:179], a[220:223], a[40:43], v[176:179]
    v_exp_f32_e64 v70, v70
    v_cvt_pk_bf16_f32 v68, v68, v69
    v_mfma_f32_16x16x32_bf16 v[180:183], a[220:223], a[72:75], v[180:183]
    s_waitcnt lgkmcnt(5)
    v_exp_f32_e32 v71, v71
    v_exp_f32_e64 v80, v80
L_s75:
    v_mfma_f32_16x16x32_bf16 v[172:175], a[224:227], a[12:15], v[172:175]
    ds_read_b128 a[220:223], v6 offset:32768
    v_cvt_pk_bf16_f32 v69, v70, v71
    v_exp_f32_e64 v81, v81
    v_mfma_f32_16x16x32_bf16 v[176:179], a[224:227], a[44:47], v[176:179]
    buffer_load_dwordx4 v4, s[16:19], s31 offen offset:3072 nt lds
    v_cvt_pk_bf16_f32 v70, v80, v81
    v_mfma_f32_16x16x32_bf16 v[180:183], a[224:227], a[76:79], v[180:183]
    s_waitcnt lgkmcnt(5)
    v_exp_f32_e32 v82, v82
    v_exp_f32_e64 v83, v83
L_s76:
    v_mfma_f32_16x16x32_bf16 v[172:175], a[228:231], a[16:19], v[172:175]
    s_add_u32 m0, s29, 16384
    s_add_u32 s31, s28, 229376
    ds_read_b128 a[224:227], v7 offset:32768
    v_cvt_pk_bf16_f32 v71, v82, v83
    v_mfma_f32_16x16x32_bf16 v[176:179], a[228:231], a[48:51], v[176:179]
    buffer_load_dwordx4 v1, s[16:19], s31 offen nt lds
    v_exp_f32_e64 v72, v72
    v_mfma_f32_16x16x32_bf16 v[180:183], a[228:231], a[80:83], v[180:183]
    s_waitcnt lgkmcnt(5)
    v_exp_f32_e32 v73, v73
    v_exp_f32_e64 v74, v74
L_s77:
    v_mfma_f32_16x16x32_bf16 v[172:175], a[204:207], a[20:23], v[172:175]
    ds_read_b128 a[228:231], v8 offset:32768
    v_cvt_pk_bf16_f32 v72, v72, v73
    v_exp_f32_e64 v75, v75
    v_mfma_f32_16x16x32_bf16 v[176:179], a[204:207], a[52:55], v[176:179]
    buffer_load_dwordx4 v2, s[16:19], s31 offen offset:1024 nt lds
    v_cvt_pk_bf16_f32 v73, v74, v75
    v_mfma_f32_16x16x32_bf16 v[180:183], a[204:207], a[84:87], v[180:183]
    s_waitcnt lgkmcnt(5)
    v_exp_f32_e32 v84, v84
L_s78:
    v_mfma_f32_16x16x32_bf16 v[172:175], a[208:211], a[24:27], v[172:175]
    ds_read_b128 a[204:207], v5 offset:33024
    v_exp_f32_e64 v85, v85
    v_mfma_f32_16x16x32_bf16 v[176:179], a[208:211], a[56:59], v[176:179]
    v_exp_f32_e64 v86, v86
    v_mfma_f32_16x16x32_bf16 v[180:183], a[208:211], a[88:91], v[180:183]
    s_waitcnt lgkmcnt(5)
    v_exp_f32_e32 v87, v87
L_s79:
    v_mfma_f32_16x16x32_bf16 v[172:175], a[212:215], a[28:31], v[172:175]
    ds_read_b128 a[208:211], v6 offset:33024
    v_cvt_pk_bf16_f32 v74, v84, v85
    v_mfma_f32_16x16x32_bf16 v[176:179], a[212:215], a[60:63], v[176:179]
    buffer_load_dwordx4 v3, s[16:19], s31 offen offset:2048 nt lds
    v_mfma_f32_16x16x32_bf16 v[180:183], a[212:215], a[92:95], v[180:183]
    s_waitcnt lgkmcnt(5)
    v_cvt_pk_bf16_f32 v75, v86, v87
L_s80:
    v_mfma_f32_16x16x32_bf16 v[184:187], a[216:219], a[0:3], 0
    ds_read_b128 a[212:215], v7 offset:33024
    v_max3_f32 v13, v13, v172, v173
    v_max3_f32 v13, v13, v174, v175
    v_max3_f32 v14, v14, v176, v177
    v_max3_f32 v14, v14, v178, v179
    v_mfma_f32_16x16x32_bf16 v[188:191], a[216:219], a[32:35], 0
    v_max3_f32 v15, v15, v180, v181
    v_max3_f32 v15, v15, v182, v183
    v_fma_f32 v28, v13, s32, -v16
    v_fma_f32 v29, v14, s32, -v17
    v_fma_f32 v30, v15, s32, -v18
    v_mfma_f32_16x16x32_bf16 v[192:195], a[216:219], a[64:67], 0
    s_waitcnt lgkmcnt(5)
    v_max3_f32 v28, v28, v29, v30
    v_cmp_lt_f32 vcc, s9, v28
    s_cbranch_vccnz L_bump1
L_back1:
    v_fma_f32 v88, v88, s32, -v16
    v_fma_f32 v89, v89, s32, -v16
    v_fma_f32 v90, v90, s32, -v16
L_s81:
    v_mfma_f32_16x16x32_bf16 v[184:187], a[220:223], a[4:7], v[184:187]
    ds_read_b128 a[216:219], v8 offset:33024
    v_fma_f32 v91, v91, s32, -v16
    v_fma_f32 v100, v100, s32, -v16
    v_fma_f32 v101, v101, s32, -v16
    v_fma_f32 v102, v102, s32, -v16
    v_mfma_f32_16x16x32_bf16 v[188:191], a[220:223], a[36:39], v[188:191]
    buffer_load_dwordx4 v4, s[16:19], s31 offen offset:3072 nt lds
    v_fma_f32 v103, v103, s32, -v16
    v_fma_f32 v92, v92, s32, -v17
    v_fma_f32 v93, v93, s32, -v17
    v_mfma_f32_16x16x32_bf16 v[192:195], a[220:223], a[68:71], v[192:195]
    v_exp_f32_e64 v88, v88
    v_fma_f32 v94, v94, s32, -v17
    v_fma_f32 v95, v95, s32, -v17
    v_fma_f32 v104, v104, s32, -v17
    v_mfma_f32_16x16x32_bf16 a[192:195], v[20:23], v[64:67], 0
    s_waitcnt lgkmcnt(5)
    v_exp_f32_e32 v89, v89
    v_fma_f32 v105, v105, s32, -v17
    v_cvt_pk_bf16_f32 v88, v88, v89
    v_fma_f32 v106, v106, s32, -v17
L_s82:
    v_mfma_f32_16x16x32_bf16 v[184:187], a[224:227], a[8:11], v[184:187]
    s_waitcnt vmcnt(12)
    s_barrier
    s_add_u32 m0, s29, 24576
    ds_read_b128 a[220:223], v5 offset:40960
    v_fma_f32 v107, v107, s32, -v17
    v_fma_f32 v96, v96, s32, -v18
    v_fma_f32 v97, v97, s32, -v18
    v_mfma_f32_16x16x32_bf16 v[188:191], a[224:227], a[40:43], v[188:191]
    s_add_u32 s31, s28, 245760
    v_exp_f32_e64 v90, v90
    v_fma_f32 v98, v98, s32, -v18
    v_fma_f32 v99, v99, s32, -v18
    v_fma_f32 v108, v108, s32, -v18
    v_mfma_f32_16x16x32_bf16 v[192:195], a[224:227], a[72:75], v[192:195]
    v_exp_f32_e64 v91, v91
    v_fma_f32 v109, v109, s32, -v18
    v_cvt_pk_bf16_f32 v89, v90, v91
    v_fma_f32 v110, v110, s32, -v18
    v_mfma_f32_16x16x32_bf16 a[196:199], v[20:23], v[68:71], 0
    s_waitcnt lgkmcnt(5)
    v_exp_f32_e32 v100, v100
    v_fma_f32 v111, v111, s32, -v18
    v_fma_f32 v112, v112, s32, -v16
    v_fma_f32 v113, v113, s32, -v16
L_s83:
    v_mfma_f32_16x16x32_bf16 v[184:187], a[228:231], a[12:15], v[184:187]
    ds_read_b128 a[224:227], v6 offset:40960
    v_fma_f32 v114, v114, s32, -v16
    v_fma_f32 v115, v115, s32, -v16
    v_fma_f32 v124, v124, s32, -v16
    v_fma_f32 v125, v125, s32, -v16
    v_mfma_f32_16x16x32_bf16 v[188:191], a[228:231], a[44:47], v[188:191]
    buffer_load_dwordx4 v1, s[16:19], s31 offen nt lds
    v_fma_f32 v126, v126, s32, -v16
    v_fma_f32 v127, v127, s32, -v16
    v_fma_f32 v116, v116, s32, -v17
    v_mfma_f32_16x16x32_bf16 v[192:195], a[228:231], a[76:79], v[192:195]
    v_exp_f32_e64 v101, v101
    v_fma_f32 v117, v117, s32, -v17
    v_cvt_pk_bf16_f32 v90, v100, v101
    v_fma_f32 v118, v118, s32, -v17
    v_mfma_f32_16x16x32_bf16 a[200:203], v[20:23], v[72:75], 0
    s_waitcnt lgkmcnt(5)
    v_exp_f32_e32 v102, v102
    v_fma_f32 v119, v119, s32, -v17
    v_fma_f32 v128, v128, s32, -v17
    v_fma_f32 v129, v129, s32, -v17
L_s84:
    v_mfma_f32_16x16x32_bf16 v[184:187], a[204:207], a[16:19], v[184:187]
    ds_read_b128 a[228:231], v7 offset:40960
    v_fma_f32 v130, v130, s32, -v17
    v_fma_f32 v131, v131, s32, -v17
    v_fma_f32 v120, v120, s32, -v18
    v_fma_f32 v121, v121, s32, -v18
    v_mfma_f32_16x16x32_bf16 v[188:191], a[204:207], a[48:51], v[188:191]
    v_exp_f32_e64 v103, v103
    v_fma_f32 v122, v122, s32, -v18
    v_cvt_pk_bf16_f32 v91, v102, v103
    v_fma_f32 v123, v123, s32, -v18
    v_mfma_f32_16x16x32_bf16 v[192:195], a[204:207], a[80:83], v[192:195]
    s_waitcnt lgkmcnt(5)
    v_exp_f32_e32 v92, v92
    v_fma_f32 v132, v132, s32, -v18
    v_fma_f32 v133, v133, s32, -v18
L_s85:
    v_mfma_f32_16x16x32_bf16 v[184:187], a[208:211], a[20:23], v[184:187]
    ds_read_b128 a[204:207], v8 offset:40960
    v_fma_f32 v134, v134, s32, -v18
    v_fma_f32 v135, v135, s32, -v18
    v_exp_f32_e64 v93, v93
    v_mfma_f32_16x16x32_bf16 v[188:191], a[208:211], a[52:55], v[188:191]
    buffer_load_dwordx4 v2, s[16:19], s31 offen offset:1024 nt lds
    v_cvt_pk_bf16_f32 v92, v92, v93
    v_exp_f32_e64 v94, v94
    v_mfma_f32_16x16x32_bf16 v[192:195], a[208:211], a[84:87], v[192:195]
    s_waitcnt lgkmcnt(5)
    v_exp_f32_e32 v95, v95
    v_exp_f32_e64 v104, v104
L_s86:
    v_mfma_f32_16x16x32_bf16 v[184:187], a[212:215], a[24:27], v[184:187]
    ds_read_b128 a[208:211], v5 offset:41216
    v_cvt_pk_bf16_f32 v93, v94, v95
    v_exp_f32_e64 v105, v105
    v_mfma_f32_16x16x32_bf16 v[188:191], a[212:215], a[56:59], v[188:191]
    v_exp_f32_e64 v106, v106
    v_cvt_pk_bf16_f32 v94, v104, v105
    v_exp_f32_e64 v107, v107
    v_mfma_f32_16x16x32_bf16 v[192:195], a[212:215], a[88:91], v[192:195]
    s_waitcnt lgkmcnt(5)
    v_exp_f32_e32 v96, v96
    v_cvt_pk_bf16_f32 v95, v106, v107
    v_exp_f32_e64 v97, v97
L_s87:
    v_mfma_f32_16x16x32_bf16 v[184:187], a[216:219], a[28:31], v[184:187]
    ds_read_b128 a[212:215], v6 offset:41216
    v_cvt_pk_bf16_f32 v96, v96, v97
    v_exp_f32_e64 v98, v98
    v_mfma_f32_16x16x32_bf16 v[188:191], a[216:219], a[60:63], v[188:191]
    buffer_load_dwordx4 v3, s[16:19], s31 offen offset:2048 nt lds
    v_exp_f32_e64 v99, v99
    v_mfma_f32_16x16x32_bf16 v[192:195], a[216:219], a[92:95], v[192:195]
    s_waitcnt lgkmcnt(5)
    v_exp_f32_e32 v108, v108
    v_cvt_pk_bf16_f32 v97, v98, v99
    v_max3_f32 v13, v13, v184, v185
L_s88:
    v_mfma_f32_16x16x32_bf16 v[196:199], a[220:223], a[0:3], 0
    ds_read_b128 a[216:219], v7 offset:41216
    v_max3_f32 v13, v13, v186, v187
    v_max3_f32 v14, v14, v188, v189
    v_max3_f32 v14, v14, v190, v191
    v_mfma_f32_16x16x32_bf16 v[200:203], a[220:223], a[32:35], 0
    v_exp_f32_e64 v109, v109
    v_max3_f32 v15, v15, v192, v193
    v_cvt_pk_bf16_f32 v98, v108, v109
    v_mfma_f32_16x16x32_bf16 v[204:207], a[220:223], a[64:67], 0
    s_waitcnt lgkmcnt(5)
    v_exp_f32_e32 v110, v110
    v_max3_f32 v15, v15, v194, v195
    v_exp_f32_e64 v111, v111
L_s89:
    v_mfma_f32_16x16x32_bf16 v[196:199], a[224:227], a[4:7], v[196:199]
    ds_read_b128 a[220:223], v8 offset:41216
    v_cvt_pk_bf16_f32 v99, v110, v111
    v_exp_f32_e64 v112, v112
    v_mfma_f32_16x16x32_bf16 v[200:203], a[224:227], a[36:39], v[200:203]
    buffer_load_dwordx4 v4, s[16:19], s31 offen offset:3072 nt lds
    v_exp_f32_e64 v113, v113
    v_mfma_f32_16x16x32_bf16 v[204:207], a[224:227], a[68:71], v[204:207]
    s_waitcnt lgkmcnt(5)
    v_exp_f32_e32 v114, v114
    v_cvt_pk_bf16_f32 v112, v112, v113
    v_exp_f32_e64 v115, v115
L_s90:
    v_mfma_f32_16x16x32_bf16 v[196:199], a[228:231], a[8:11], v[196:199]
    s_waitcnt vmcnt(12)
    s_barrier
    s_add_u32 m0, s29, 32768
    ds_read_b128 a[224:227], v5 offset:0
    v_cvt_pk_bf16_f32 v113, v114, v115
    v_exp_f32_e64 v124, v124
    v_mfma_f32_16x16x32_bf16 v[200:203], a[228:231], a[40:43], v[200:203]
    s_add_u32 s31, s63, 0
    v_exp_f32_e32 v125, v125
    v_exp_f32_e64 v126, v126
    v_mfma_f32_16x16x32_bf16 v[204:207], a[228:231], a[72:75], v[204:207]
    s_waitcnt lgkmcnt(5)
    v_exp_f32_e32 v127, v127
    v_cvt_pk_bf16_f32 v114, v124, v125
    v_cvt_pk_bf16_f32 v115, v126, v127
L_s91:
    v_mfma_f32_16x16x32_bf16 v[196:199], a[204:207], a[12:15], v[196:199]
    ds_read_b128 a[228:231], v6 offset:0
    v_exp_f32_e64 v116, v116
    v_mfma_f32_16x16x32_bf16 v[200:203], a[204:207], a[44:47], v[200:203]
    buffer_load_dwordx4 v19, s[20:23], s31 offen nt lds
    v_exp_f32_e64 v117, v117
    v_mfma_f32_16x16x32_bf16 v[204:207], a[204:207], a[76:79], v[204:207]
    s_waitcnt lgkmcnt(5)
    v_exp_f32_e32 v118, v118
    v_cvt_pk_bf16_f32 v116, v116, v117
    v_exp_f32_e64 v119, v119
L_s92:
    v_mfma_f32_16x16x32_bf16 v[196:199], a[208:211], a[16:19], v[196:199]
    s_add_u32 s31, s63, 3072
    ds_read_b128 a[204:207], v7 offset:0
    v_cvt_pk_bf16_f32 v117, v118, v119
    v_exp_f32_e64 v128, v128
    v_mfma_f32_16x16x32_bf16 v[200:203], a[208:211], a[48:51], v[200:203]
    v_exp_f32_e64 v129, v129
    v_exp_f32_e64 v130, v130
    v_mfma_f32_16x16x32_bf16 v[204:207], a[208:211], a[80:83], v[204:207]
    s_waitcnt lgkmcnt(5)
    v_exp_f32_e32 v131, v131
    v_cvt_pk_bf16_f32 v118, v128, v129
    v_cvt_pk_bf16_f32 v119, v130, v131
L_s93:
    v_mfma_f32_16x16x32_bf16 v[196:199], a[212:215], a[20:23], v[196:199]
    ds_read_b128 a[208:211], v8 offset:0
    v_exp_f32_e64 v120, v120
    v_mfma_f32_16x16x32_bf16 v[200:203], a[212:215], a[52:55], v[200:203]
    buffer_load_dwordx4 v19, s[20:23], s31 offen offset:1024 nt lds
    v_exp_f32_e64 v121, v121
    v_mfma_f32_16x16x32_bf16 v[204:207], a[212:215], a[84:87], v[204:207]
    s_waitcnt lgkmcnt(5)
    v_exp_f32_e32 v122, v122
    v_cvt_pk_bf16_f32 v120, v120, v121
L_s94:
    v_mfma_f32_16x16x32_bf16 v[196:199], a[216:219], a[24:27], v[196:199]
    s_add_u32 s31, s63, 14336
    ds_read_b128 a[212:215], v5 offset:256
    v_exp_f32_e64 v123, v123
    v_mfma_f32_16x16x32_bf16 v[200:203], a[216:219], a[56:59], v[200:203]
    v_exp_f32_e64 v132, v132
    v_cvt_pk_bf16_f32 v121, v122, v123
    v_mfma_f32_16x16x32_bf16 v[204:207], a[216:219], a[88:91], v[204:207]
    s_waitcnt lgkmcnt(5)
    v_exp_f32_e32 v133, v133
    v_exp_f32_e64 v134, v134
L_s95:
    v_mfma_f32_16x16x32_bf16 v[196:199], a[220:223], a[28:31], v[196:199]
    ds_read_b128 a[216:219], v6 offset:256
    v_cvt_pk_bf16_f32 v122, v132, v133
    v_mfma_f32_16x16x32_bf16 v[200:203], a[220:223], a[60:63], v[200:203]
    buffer_load_dwordx4 v19, s[20:23], s31 offen offset:2048 nt lds
    v_exp_f32_e64 v135, v135
    v_mfma_f32_16x16x32_bf16 v[204:207], a[220:223], a[92:95], v[204:207]
    s_waitcnt lgkmcnt(5)
    v_cvt_pk_bf16_f32 v123, v134, v135
    v_max3_f32 v13, v13, v196, v197
    v_max3_f32 v13, v13, v198, v199
    v_fma_f32 v28, v13, s32, -v16
    v_max3_f32 v14, v14, v200, v201
L_s96:
    v_mfma_f32_16x16x32_bf16 v[208:211], a[224:227], a[0:3], 0
    s_add_u32 s31, s63, 17408
    ds_read_b128 a[220:223], v7 offset:256
    v_max3_f32 v14, v14, v202, v203
    v_max3_f32 v15, v15, v204, v205
    v_max3_f32 v15, v15, v206, v207
    v_fma_f32 v29, v14, s32, -v17
    v_mfma_f32_16x16x32_bf16 v[212:215], a[224:227], a[32:35], 0
    v_fma_f32 v30, v15, s32, -v18
    v_max3_f32 v28, v28, v29, v30
    v_cmp_lt_f32 vcc, s9, v28
    s_cbranch_vccnz L_bump3
L_back3:
    v_fma_f32 v136, v136, s32, -v16
    v_fma_f32 v137, v137, s32, -v16
    v_mfma_f32_16x16x32_bf16 v[216:219], a[224:227], a[64:67], 0
    s_waitcnt lgkmcnt(5)
    v_exp_f32_e64 v136, v136
    v_fma_f32 v138, v138, s32, -v16
    v_fma_f32 v139, v139, s32, -v16
    v_fma_f32 v148, v148, s32, -v16
L_s97:
    v_mfma_f32_16x16x32_bf16 v[208:211], a[228:231], a[4:7], v[208:211]
    ds_read_b128 a[224:227], v8 offset:256
    v_fma_f32 v149, v149, s32, -v16
    v_fma_f32 v150, v150, s32, -v16
    v_fma_f32 v151, v151, s32, -v16
    v_mfma_f32_16x16x32_bf16 v[212:215], a[228:231], a[36:39], v[212:215]
    buffer_load_dwordx4 v19, s[20:23], s31 offen offset:3072 nt lds
    v_fma_f32 v140, v140, s32, -v17
    v_fma_f32 v141, v141, s32, -v17
    v_mfma_f32_16x16x32_bf16 v[216:219], a[228:231], a[68:71], v[216:219]
    v_exp_f32_e64 v137, v137
    v_fma_f32 v142, v142, s32, -v17
    v_cvt_pk_bf16_f32 v136, v136, v137
    v_mfma_f32_16x16x32_bf16 a[192:195], v[20:23], v[88:91], a[192:195]
    s_waitcnt lgkmcnt(5)
    v_exp_f32_e32 v138, v138
    v_fma_f32 v143, v143, s32, -v17
    v_fma_f32 v152, v152, s32, -v17
L_s98:
    v_mfma_f32_16x16x32_bf16 v[208:211], a[204:207], a[8:11], v[208:211]
    s_waitcnt vmcnt(12)
    s_barrier
    s_add_u32 m0, s29, 40960
    ds_read_b128 a[228:231], v5 offset:8192
    v_fma_f32 v153, v153, s32, -v17
    v_fma_f32 v154, v154, s32, -v17
    v_mfma_f32_16x16x32_bf16 v[212:215], a[204:207], a[40:43], v[212:215]
    s_add_u32 s31, s62, 0
    global_load_dword v24, v52, s[56:57] sc1
    v_fma_f32 v155, v155, s32, -v17
    v_fma_f32 v144, v144, s32, -v18
    v_mfma_f32_16x16x32_bf16 v[216:219], a[204:207], a[72:75], v[216:219]
    v_exp_f32_e32 v139, v139
    v_fma_f32 v145, v145, s32, -v18
    v_cvt_pk_bf16_f32 v137, v138, v139
    v_mfma_f32_16x16x32_bf16 a[196:199], v[20:23], v[92:95], a[196:199]
    s_waitcnt lgkmcnt(5)
    v_exp_f32_e32 v148, v148
    v_fma_f32 v146, v146, s32, -v18
    v_fma_f32 v147, v147, s32, -v18
L_s99:
    v_mfma_f32_16x16x32_bf16 v[208:211], a[208:211], a[12:15], v[208:211]
    ds_read_b128 a[204:207], v6 offset:8192
    v_fma_f32 v156, v156, s32, -v18
    v_fma_f32 v157, v157, s32, -v18
    v_fma_f32 v158, v158, s32, -v18
    v_mfma_f32_16x16x32_bf16 v[212:215], a[208:211], a[44:47], v[212:215]
    buffer_load_dwordx4 v19, s[20:23], s31 offen nt lds
    v_fma_f32 v159, v159, s32, -v18
    v_fma_f32 v160, v160, s32, -v16
    v_mfma_f32_16x16x32_bf16 v[216:219], a[208:211], a[76:79], v[216:219]
    v_exp_f32_e64 v149, v149
    v_fma_f32 v161, v161, s32, -v16
    v_cvt_pk_bf16_f32 v138, v148, v149
    v_mfma_f32_16x16x32_bf16 a[200:203], v[20:23], v[96:99], a[200:203]
    s_waitcnt lgkmcnt(5)
    v_exp_f32_e32 v150, v150
    v_fma_f32 v162, v162, s32, -v16
    v_fma_f32 v163, v163, s32, -v16
L_s100:
    v_mfma_f32_16x16x32_bf16 v[208:211], a[212:215], a[16:19], v[208:211]
    s_add_u32 s31, s62, 3072
    ds_read_b128 a[208:211], v7 offset:8192
    v_fma_f32 v172, v172, s32, -v16
    v_fma_f32 v173, v173, s32, -v16
    v_fma_f32 v174, v174, s32, -v16
    v_mfma_f32_16x16x32_bf16 v[212:215], a[212:215], a[48:51], v[212:215]
    v_exp_f32_e64 v151, v151
    v_fma_f32 v175, v175, s32, -v16
    v_cvt_pk_bf16_f32 v139, v150, v151
    v_mfma_f32_16x16x32_bf16 v[216:219], a[212:215], a[80:83], v[216:219]
    s_waitcnt lgkmcnt(5)
    v_exp_f32_e32 v140, v140
    v_fma_f32 v164, v164, s32, -v17
    v_fma_f32 v165, v165, s32, -v17
L_s101:
    v_mfma_f32_16x16x32_bf16 v[208:211], a[216:219], a[20:23], v[208:211]
    ds_read_b128 a[212:215], v8 offset:8192
    v_fma_f32 v166, v166, s32, -v17
    v_fma_f32 v167, v167, s32, -v17
    v_fma_f32 v176, v176, s32, -v17
    v_mfma_f32_16x16x32_bf16 v[212:215], a[216:219], a[52:55], v[212:215]
    buffer_load_dwordx4 v19, s[20:23], s31 offen offset:1024 nt lds
    v_fma_f32 v177, v177, s32, -v17
    v_fma_f32 v178, v178, s32, -v17
    v_mfma_f32_16x16x32_bf16 v[216:219], a[216:219], a[84:87], v[216:219]
    v_exp_f32_e64 v141, v141
    v_fma_f32 v179, v179, s32, -v17
    v_cvt_pk_bf16_f32 v140, v140, v141
    v_mfma_f32_16x16x32_bf16 a[192:195], v[20:23], v[112:115], a[192:195]
    s_waitcnt lgkmcnt(5)
    v_exp_f32_e32 v142, v142
    v_fma_f32 v168, v168, s32, -v18
    v_fma_f32 v169, v169, s32, -v18
L_s102:
    v_mfma_f32_16x16x32_bf16 v[208:211], a[220:223], a[24:27], v[208:211]
    s_add_u32 s31, s62, 14336
    ds_read_b128 a[216:219], v5 offset:8448
    v_fma_f32 v170, v170, s32, -v18
    v_fma_f32 v171, v171, s32, -v18
    v_fma_f32 v180, v180, s32, -v18
    v_mfma_f32_16x16x32_bf16 v[212:215], a[220:223], a[56:59], v[212:215]
    v_exp_f32_e64 v143, v143
    v_fma_f32 v181, v181, s32, -v18
    v_cvt_pk_bf16_f32 v141, v142, v143
    v_mfma_f32_16x16x32_bf16 v[216:219], a[220:223], a[88:91], v[216:219]
    v_exp_f32_e64 v152, v152
    v_fma_f32 v182, v182, s32, -v18
    v_fma_f32 v183, v183, s32, -v18
    v_mfma_f32_16x16x32_bf16 a[196:199], v[20:23], v[116:119], a[196:199]
    s_waitcnt lgkmcnt(5)
    v_exp_f32_e32 v153, v153
    v_exp_f32_e64 v154, v154
L_s103:
    v_mfma_f32_16x16x32_bf16 v[208:211], a[224:227], a[28:31], v[208:211]
    ds_read_b128 a[220:223], v6 offset:8448
    v_cvt_pk_bf16_f32 v142, v152, v153
    v_exp_f32_e64 v155, v155
    v_mfma_f32_16x16x32_bf16 v[212:215], a[224:227], a[60:63], v[212:215]
    buffer_load_dwordx4 v19, s[20:23], s31 offen offset:2048 nt lds
    v_cvt_pk_bf16_f32 v143, v154, v155
    v_exp_f32_e64 v144, v144
    v_mfma_f32_16x16x32_bf16 v[216:219], a[224:227], a[92:95], v[216:219]
    v_exp_f32_e64 v145, v145
    v_max3_f32 v13, v13, v208, v209
    v_cvt_pk_bf16_f32 v144, v144, v145
    v_mfma_f32_16x16x32_bf16 a[200:203], v[20:23], v[120:123], a[200:203]
    s_waitcnt lgkmcnt(5)
    v_exp_f32_e32 v146, v146
    v_max3_f32 v13, v13, v210, v211
    v_max3_f32 v14, v14, v212, v213
L_s104:
    v_mfma_f32_16x16x32_bf16 v[220:223], a[228:231], a[0:3], 0
    s_add_u32 s31, s62, 17408
    ds_read_b128 a[224:227], v7 offset:8448
    v_max3_f32 v14, v14, v214, v215
    v_max3_f32 v15, v15, v216, v217
    v_max3_f32 v15, v15, v218, v219
    v_mfma_f32_16x16x32_bf16 v[224:227], a[228:231], a[32:35], 0
    v_exp_f32_e64 v147, v147
    v_exp_f32_e64 v156, v156
    v_mfma_f32_16x16x32_bf16 v[228:231], a[228:231], a[64:67], 0
    s_waitcnt lgkmcnt(5)
    v_exp_f32_e32 v157, v157
    v_cvt_pk_bf16_f32 v145, v146, v147
    v_cvt_pk_bf16_f32 v146, v156, v157
L_s105:
    v_mfma_f32_16x16x32_bf16 v[220:223], a[204:207], a[4:7], v[220:223]
    ds_read_b128 a[228:231], v8 offset:8448
    v_exp_f32_e64 v158, v158
    v_mfma_f32_16x16x32_bf16 v[224:227], a[204:207], a[36:39], v[224:227]
    buffer_load_dwordx4 v19, s[20:23], s31 offen offset:3072 nt lds
    v_exp_f32_e64 v159, v159
    v_mfma_f32_16x16x32_bf16 v[228:231], a[204:207], a[68:71], v[228:231]
    s_waitcnt lgkmcnt(5)
    v_exp_f32_e32 v160, v160
    v_cvt_pk_bf16_f32 v147, v158, v159
    v_exp_f32_e64 v161, v161
L_s106:
    v_mfma_f32_16x16x32_bf16 v[220:223], a[208:211], a[8:11], v[220:223]
    s_waitcnt vmcnt(13)
    s_barrier
    s_add_u32 m0, s29, 0
    ds_read_b128 a[204:207], v5 offset:16384
    v_cvt_pk_bf16_f32 v160, v160, v161
    v_exp_f32_e32 v162, v162
    v_mfma_f32_16x16x32_bf16 v[224:227], a[208:211], a[40:43], v[224:227]
    s_add_u32 s31, s63, 65536
    v_exp_f32_e64 v163, v163
    v_exp_f32_e64 v172, v172
    v_mfma_f32_16x16x32_bf16 v[228:231], a[208:211], a[72:75], v[228:231]
    s_waitcnt lgkmcnt(5)
    v_exp_f32_e32 v173, v173
    v_cvt_pk_bf16_f32 v161, v162, v163
    v_cvt_pk_bf16_f32 v162, v172, v173
L_s107:
    v_mfma_f32_16x16x32_bf16 v[220:223], a[212:215], a[12:15], v[220:223]
    ds_read_b128 a[208:211], v6 offset:16384
    v_exp_f32_e64 v174, v174
    v_mfma_f32_16x16x32_bf16 v[224:227], a[212:215], a[44:47], v[224:227]
    buffer_load_dwordx4 v19, s[20:23], s31 offen nt lds
    v_exp_f32_e64 v175, v175
    v_mfma_f32_16x16x32_bf16 v[228:231], a[212:215], a[76:79], v[228:231]
    s_waitcnt lgkmcnt(5)
    v_exp_f32_e32 v164, v164
    v_cvt_pk_bf16_f32 v163, v174, v175
    v_exp_f32_e64 v165, v165
L_s108:
    v_mfma_f32_16x16x32_bf16 v[220:223], a[216:219], a[16:19], v[220:223]
    s_add_u32 s31, s63, 68608
    ds_read_b128 a[212:215], v7 offset:16384
    v_cvt_pk_bf16_f32 v164, v164, v165
    v_exp_f32_e64 v166, v166
    v_mfma_f32_16x16x32_bf16 v[224:227], a[216:219], a[48:51], v[224:227]
    v_exp_f32_e64 v167, v167
    v_exp_f32_e64 v176, v176
    v_mfma_f32_16x16x32_bf16 v[228:231], a[216:219], a[80:83], v[228:231]
    s_waitcnt lgkmcnt(5)
    v_exp_f32_e32 v177, v177
    v_cvt_pk_bf16_f32 v165, v166, v167
    v_cvt_pk_bf16_f32 v166, v176, v177
L_s109:
    v_mfma_f32_16x16x32_bf16 v[220:223], a[220:223], a[20:23], v[220:223]
    ds_read_b128 a[216:219], v8 offset:16384
    v_exp_f32_e64 v178, v178
    v_mfma_f32_16x16x32_bf16 v[224:227], a[220:223], a[52:55], v[224:227]
    buffer_load_dwordx4 v19, s[20:23], s31 offen offset:1024 nt lds
    v_exp_f32_e64 v179, v179
    v_mfma_f32_16x16x32_bf16 v[228:231], a[220:223], a[84:87], v[228:231]
    s_waitcnt lgkmcnt(5)
    v_exp_f32_e32 v168, v168
    v_cvt_pk_bf16_f32 v167, v178, v179
    v_exp_f32_e64 v169, v169
L_s110:
    v_mfma_f32_16x16x32_bf16 v[220:223], a[224:227], a[24:27], v[220:223]
    s_add_u32 s31, s63, 79872
    ds_read_b128 a[220:223], v5 offset:16640
    v_cvt_pk_bf16_f32 v168, v168, v169
    v_exp_f32_e64 v170, v170
    v_mfma_f32_16x16x32_bf16 v[224:227], a[224:227], a[56:59], v[224:227]
    v_exp_f32_e64 v171, v171
    v_exp_f32_e64 v180, v180
    v_mfma_f32_16x16x32_bf16 v[228:231], a[224:227], a[88:91], v[228:231]
    s_waitcnt lgkmcnt(5)
    v_exp_f32_e32 v181, v181
    v_cvt_pk_bf16_f32 v169, v170, v171
    v_cvt_pk_bf16_f32 v170, v180, v181
L_s111:
    v_mfma_f32_16x16x32_bf16 v[220:223], a[228:231], a[28:31], v[220:223]
    ds_read_b128 a[224:227], v6 offset:16640
    v_exp_f32_e64 v182, v182
    v_mfma_f32_16x16x32_bf16 v[224:227], a[228:231], a[60:63], v[224:227]
    buffer_load_dwordx4 v19, s[20:23], s31 offen offset:2048 nt lds
    v_exp_f32_e64 v183, v183
    v_mfma_f32_16x16x32_bf16 v[228:231], a[228:231], a[92:95], v[228:231]
    s_waitcnt lgkmcnt(5)
    v_cvt_pk_bf16_f32 v171, v182, v183
    v_max3_f32 v13, v13, v220, v221
    v_max3_f32 v13, v13, v222, v223
L_s112:
    v_mfma_f32_16x16x32_bf16 v[232:235], a[204:207], a[0:3], 0
    s_add_u32 s31, s63, 82944
    ds_read_b128 a[228:231], v7 offset:16640
    v_max3_f32 v14, v14, v224, v225
    v_max3_f32 v14, v14, v226, v227
    v_mfma_f32_16x16x32_bf16 v[236:239], a[204:207], a[32:35], 0
    v_max3_f32 v15, v15, v228, v229
    v_max3_f32 v15, v15, v230, v231
    v_fma_f32 v28, v13, s32, -v16
    v_mfma_f32_16x16x32_bf16 v[240:243], a[204:207], a[64:67], 0
    s_waitcnt lgkmcnt(5)
    v_fma_f32 v29, v14, s32, -v17
    v_fma_f32 v30, v15, s32, -v18
    v_max3_f32 v28, v28, v29, v30
L_s113:
    v_mfma_f32_16x16x32_bf16 v[232:235], a[208:211], a[4:7], v[232:235]
    ds_read_b128 a[204:207], v8 offset:16640
    v_cmp_lt_f32 vcc, s9, v28
    s_cbranch_vccnz L_bump5
L_back5:
    v_fma_f32 v184, v184, s32, -v16
    v_mfma_f32_16x16x32_bf16 v[236:239], a[208:211], a[36:39], v[236:239]
    buffer_load_dwordx4 v19, s[20:23], s31 offen offset:3072 nt lds
    v_fma_f32 v185, v185, s32, -v16
    v_mfma_f32_16x16x32_bf16 v[240:243], a[208:211], a[68:71], v[240:243]
    v_exp_f32_e64 v184, v184
    v_fma_f32 v186, v186, s32, -v16
    v_mfma_f32_16x16x32_bf16 a[192:195], v[20:23], v[136:139], a[192:195]
    s_waitcnt lgkmcnt(5)
    v_exp_f32_e32 v185, v185
    v_fma_f32 v187, v187, s32, -v16
L_s114:
    v_mfma_f32_16x16x32_bf16 v[232:235], a[212:215], a[8:11], v[232:235]
    s_waitcnt vmcnt(13)
    s_barrier
    s_add_u32 m0, s29, 8192
    ds_read_b128 a[208:211], v5 offset:24576
    v_fma_f32 v196, v196, s32, -v16
    v_mfma_f32_16x16x32_bf16 v[236:239], a[212:215], a[40:43], v[236:239]
    s_add_u32 s31, s62, 65536
    v_exp_f32_e64 v186, v186
    v_fma_f32 v197, v197, s32, -v16
    v_mfma_f32_16x16x32_bf16 v[240:243], a[212:215], a[72:75], v[240:243]
    v_exp_f32_e64 v187, v187
    v_fma_f32 v198, v198, s32, -v16
    v_mfma_f32_16x16x32_bf16 a[196:199], v[20:23], v[140:143], a[196:199]
    s_waitcnt lgkmcnt(5)
    v_exp_f32_e32 v196, v196
    v_fma_f32 v199, v199, s32, -v16
L_s115:
    v_mfma_f32_16x16x32_bf16 v[232:235], a[216:219], a[12:15], v[232:235]
    ds_read_b128 a[212:215], v6 offset:24576
    v_cvt_pk_bf16_f32 v184, v184, v185
    v_cvt_pk_bf16_f32 v185, v186, v187
    v_mfma_f32_16x16x32_bf16 v[236:239], a[216:219], a[44:47], v[236:239]
    buffer_load_dwordx4 v19, s[20:23], s31 offen nt lds
    v_fma_f32 v188, v188, s32, -v17
    v_mfma_f32_16x16x32_bf16 v[240:243], a[216:219], a[76:79], v[240:243]
    v_exp_f32_e64 v197, v197
    v_fma_f32 v189, v189, s32, -v17
    v_mfma_f32_16x16x32_bf16 a[200:203], v[20:23], v[144:147], a[200:203]
    s_waitcnt lgkmcnt(5)
    v_exp_f32_e32 v198, v198
    v_cvt_pk_bf16_f32 v186, v196, v197
L_s116:
    v_mfma_f32_16x16x32_bf16 v[232:235], a[220:223], a[16:19], v[232:235]
    s_add_u32 s31, s62, 68608
    ds_read_b128 a[216:219], v7 offset:24576
    v_fma_f32 v190, v190, s32, -v17
    v_fma_f32 v191, v191, s32, -v17
    v_mfma_f32_16x16x32_bf16 v[236:239], a[220:223], a[48:51], v[236:239]
    v_exp_f32_e64 v199, v199
    v_fma_f32 v200, v200, s32, -v17
    v_mfma_f32_16x16x32_bf16 v[240:243], a[220:223], a[80:83], v[240:243]
    s_waitcnt lgkmcnt(5)
    v_exp_f32_e32 v188, v188
    v_cvt_pk_bf16_f32 v187, v198, v199
L_s117:
    v_mfma_f32_16x16x32_bf16 v[232:235], a[224:227], a[20:23], v[232:235]
    ds_read_b128 a[220:223], v8 offset:24576
    v_fma_f32 v201, v201, s32, -v17
    v_fma_f32 v202, v202, s32, -v17
    v_mfma_f32_16x16x32_bf16 v[236:239], a[224:227], a[52:55], v[236:239]
    buffer_load_dwordx4 v19, s[20:23], s31 offen offset:1024 nt lds
    v_fma_f32 v203, v203, s32, -v17
    v_mfma_f32_16x16x32_bf16 v[240:243], a[224:227], a[84:87], v[240:243]
    v_exp_f32_e64 v189, v189
    v_fma_f32 v192, v192, s32, -v18
    v_mfma_f32_16x16x32_bf16 a[192:195], v[20:23], v[160:163], a[192:195]
    s_waitcnt lgkmcnt(5)
    v_exp_f32_e32 v190, v190
    v_cvt_pk_bf16_f32 v188, v188, v189
L_s118:
    v_mfma_f32_16x16x32_bf16 v[232:235], a[228:231], a[24:27], v[232:235]
    s_add_u32 s31, s62, 79872
    ds_read_b128 a[224:227], v5 offset:24832
    v_fma_f32 v193, v193, s32, -v18
    v_fma_f32 v194, v194, s32, -v18
    v_mfma_f32_16x16x32_bf16 v[236:239], a[228:231], a[56:59], v[236:239]
    v_exp_f32_e64 v191, v191
    v_fma_f32 v195, v195, s32, -v18
    v_mfma_f32_16x16x32_bf16 v[240:243], a[228:231], a[88:91], v[240:243]
    v_exp_f32_e64 v200, v200
    v_cvt_pk_bf16_f32 v189, v190, v191
    v_mfma_f32_16x16x32_bf16 a[196:199], v[20:23], v[164:167], a[196:199]
    s_waitcnt lgkmcnt(5)
    v_exp_f32_e32 v201, v201
    v_fma_f32 v204, v204, s32, -v18
L_s119:
    v_mfma_f32_16x16x32_bf16 v[232:235], a[204:207], a[28:31], v[232:235]
    ds_read_b128 a[228:231], v6 offset:24832
    v_cvt_pk_bf16_f32 v190, v200, v201
    v_fma_f32 v205, v205, s32, -v18
    v_mfma_f32_16x16x32_bf16 v[236:239], a[204:207], a[60:63], v[236:239]
    buffer_load_dwordx4 v19, s[20:23], s31 offen offset:2048 nt lds
    v_fma_f32 v206, v206, s32, -v18
    v_mfma_f32_16x16x32_bf16 v[240:243], a[204:207], a[92:95], v[240:243]
    v_exp_f32_e64 v202, v202
    v_fma_f32 v207, v207, s32, -v18
    v_mfma_f32_16x16x32_bf16 a[200:203], v[20:23], v[168:171], a[200:203]
    s_waitcnt lgkmcnt(5)
    v_exp_f32_e32 v203, v203
    v_max3_f32 v13, v13, v232, v233
L_s120:
    v_mfma_f32_16x16x32_bf16 v[244:247], a[208:211], a[0:3], 0
    s_add_u32 s31, s62, 82944
    ds_read_b128 a[204:207], v7 offset:24832
    v_cvt_pk_bf16_f32 v191, v202, v203
    v_max3_f32 v13, v13, v234, v235
    v_mfma_f32_16x16x32_bf16 v[248:251], a[208:211], a[32:35], 0
    v_exp_f32_e64 v192, v192
    v_mfma_f32_16x16x32_bf16 v[252:255], a[208:211], a[64:67], 0
    s_waitcnt lgkmcnt(5)
    v_exp_f32_e32 v193, v193
L_s121:
    v_mfma_f32_16x16x32_bf16 v[244:247], a[212:215], a[4:7], v[244:247]
    ds_read_b128 a[208:211], v8 offset:24832
    v_cvt_pk_bf16_f32 v192, v192, v193
    v_mfma_f32_16x16x32_bf16 v[248:251], a[212:215], a[36:39], v[248:251]
    buffer_load_dwordx4 v19, s[20:23], s31 offen offset:3072 nt lds
    v_mfma_f32_16x16x32_bf16 v[252:255], a[212:215], a[68:71], v[252:255]
    s_waitcnt lgkmcnt(5)
    v_exp_f32_e32 v194, v194
L_s122:
    v_mfma_f32_16x16x32_bf16 v[244:247], a[216:219], a[8:11], v[244:247]
    s_waitcnt vmcnt(13)
    s_barrier
    s_add_u32 m0, s29, 16384
    ds_read_b64_tr_b16 a[212:213], v9 offset:32768
    ds_read_b64_tr_b16 a[214:215], v9 offset:34816
    v_mfma_f32_16x16x32_bf16 v[248:251], a[216:219], a[40:43], v[248:251]
    s_add_u32 s31, s63, 131072
    v_exp_f32_e64 v195, v195
    v_mfma_f32_16x16x32_bf16 v[252:255], a[216:219], a[72:75], v[252:255]
    s_waitcnt lgkmcnt(6)
    v_exp_f32_e32 v204, v204
L_s123:
    v_mfma_f32_16x16x32_bf16 v[244:247], a[220:223], a[12:15], v[244:247]
    ds_read_b64_tr_b16 a[216:217], v10 offset:32768
    ds_read_b64_tr_b16 a[218:219], v10 offset:34816
    v_mfma_f32_16x16x32_bf16 v[248:251], a[220:223], a[44:47], v[248:251]
    buffer_load_dwordx4 v19, s[20:23], s31 offen nt lds
    v_mfma_f32_16x16x32_bf16 v[252:255], a[220:223], a[76:79], v[252:255]
    s_waitcnt lgkmcnt(7)
    v_exp_f32_e32 v205, v205
L_s124:
    v_mfma_f32_16x16x32_bf16 v[244:247], a[224:227], a[16:19], v[244:247]
    s_add_u32 s31, s63, 134144
    ds_read_b64_tr_b16 a[220:221], v11 offset:32768
    ds_read_b64_tr_b16 a[222:223], v11 offset:34816
    v_mfma_f32_16x16x32_bf16 v[248:251], a[224:227], a[48:51], v[248:251]
    v_exp_f32_e64 v206, v206
    v_mfma_f32_16x16x32_bf16 v[252:255], a[224:227], a[80:83], v[252:255]
    s_waitcnt lgkmcnt(8)
    v_exp_f32_e32 v207, v207
L_s125:
    v_mfma_f32_16x16x32_bf16 v[244:247], a[228:231], a[20:23], v[244:247]
    ds_read_b64_tr_b16 a[224:225], v12 offset:32768
    ds_read_b64_tr_b16 a[226:227], v12 offset:34816
    v_mfma_f32_16x16x32_bf16 v[248:251], a[228:231], a[52:55], v[248:251]
    buffer_load_dwordx4 v19, s[20:23], s31 offen offset:1024 nt lds
    v_mfma_f32_16x16x32_bf16 v[252:255], a[228:231], a[84:87], v[252:255]
    s_waitcnt lgkmcnt(9)
    v_cvt_pk_bf16_f32 v193, v194, v195
    v_cvt_pk_bf16_f32 v194, v204, v205
L_s126:
    v_mfma_f32_16x16x32_bf16 v[244:247], a[204:207], a[24:27], v[244:247]
    s_add_u32 s31, s63, 145408
    ds_read_b64_tr_b16 a[228:229], v9 offset:36864
    v_cvt_pk_bf16_f32 v195, v206, v207
    v_mfma_f32_16x16x32_bf16 v[248:251], a[204:207], a[56:59], v[248:251]
    ds_read_b64_tr_b16 a[230:231], v9 offset:38912
    v_max3_f32 v14, v14, v236, v237
    v_mfma_f32_16x16x32_bf16 v[252:255], a[204:207], a[88:91], v[252:255]
    s_waitcnt lgkmcnt(10)
    v_max3_f32 v14, v14, v238, v239
    v_max3_f32 v15, v15, v240, v241
L_s127:
    v_mfma_f32_16x16x32_bf16 v[244:247], a[208:211], a[28:31], v[244:247]
    ds_read_b64_tr_b16 a[204:205], v10 offset:36864
    ds_read_b64_tr_b16 a[206:207], v10 offset:38912
    v_mfma_f32_16x16x32_bf16 v[248:251], a[208:211], a[60:63], v[248:251]
    buffer_load_dwordx4 v19, s[20:23], s31 offen offset:2048 nt lds
    v_mfma_f32_16x16x32_bf16 v[252:255], a[208:211], a[92:95], v[252:255]
    s_waitcnt lgkmcnt(10)
    v_max3_f32 v15, v15, v242, v243
    s_nop 6
    v_max3_f32 v13, v13, v244, v245
    v_max3_f32 v13, v13, v246, v247
    v_max3_f32 v14, v14, v248, v249
    v_max3_f32 v14, v14, v250, v251
    v_max3_f32 v15, v15, v252, v253
    v_max3_f32 v15, v15, v254, v255
    v_fma_f32 v28, v13, s32, -v16
    v_fma_f32 v29, v14, s32, -v17
    v_fma_f32 v30, v15, s32, -v18
    v_max3_f32 v28, v28, v29, v30
    v_cmp_lt_f32 vcc, s9, v28
    s_cbranch_vccnz L_bump6
L_back6:
L_s128:
    v_mfma_f32_16x16x32_bf16 a[48:51], a[212:215], v[64:67], 0
    s_add_u32 s31, s63, 148480
    ds_read_b64_tr_b16 a[208:209], v11 offset:36864
    v_fma_f32 v208, v208, s32, -v16
    v_fma_f32 v209, v209, s32, -v16
    v_mfma_f32_16x16x32_bf16 a[52:55], a[212:215], v[68:71], 0
    ds_read_b64_tr_b16 a[210:211], v11 offset:38912
    v_fma_f32 v210, v210, s32, -v16
    v_fma_f32 v211, v211, s32, -v16
    v_mfma_f32_16x16x32_bf16 a[56:59], a[212:215], v[72:75], 0
    s_waitcnt lgkmcnt(10)
    v_exp_f32_e32 v208, v208
    v_fma_f32 v220, v220, s32, -v16
L_s129:
    v_mfma_f32_16x16x32_bf16 a[60:63], a[216:219], v[64:67], 0
    ds_read_b64_tr_b16 a[212:213], v12 offset:36864
    ds_read_b64_tr_b16 a[214:215], v12 offset:38912
    v_fma_f32 v221, v221, s32, -v16
    v_mfma_f32_16x16x32_bf16 a[64:67], a[216:219], v[68:71], 0
    buffer_load_dwordx4 v19, s[20:23], s31 offen offset:3072 nt lds
    v_fma_f32 v222, v222, s32, -v16
    v_mfma_f32_16x16x32_bf16 a[68:71], a[216:219], v[72:75], 0
    s_waitcnt lgkmcnt(10)
    v_exp_f32_e32 v209, v209
    v_fma_f32 v223, v223, s32, -v16
L_s130:
    v_mfma_f32_16x16x32_bf16 a[72:75], a[220:223], v[64:67], 0
    s_waitcnt vmcnt(12)
    s_barrier
    s_add_u32 m0, s29, 24576
    ds_read_b64_tr_b16 a[216:217], v9 offset:40960
    ds_read_b64_tr_b16 a[218:219], v9 offset:43008
    v_cvt_pk_bf16_f32 v208, v208, v209
    v_mfma_f32_16x16x32_bf16 a[76:79], a[220:223], v[68:71], 0
    s_add_u32 s31, s63, 196608
    v_exp_f32_e64 v210, v210
    v_fma_f32 v212, v212, s32, -v17
    v_mfma_f32_16x16x32_bf16 a[80:83], a[220:223], v[72:75], 0
    s_waitcnt lgkmcnt(10)
    v_exp_f32_e32 v211, v211
    v_fma_f32 v213, v213, s32, -v17
L_s131:
    v_mfma_f32_16x16x32_bf16 a[84:87], a[224:227], v[64:67], 0
    ds_read_b64_tr_b16 a[220:221], v10 offset:40960
    ds_read_b64_tr_b16 a[222:223], v10 offset:43008
    v_cvt_pk_bf16_f32 v209, v210, v211
    v_mfma_f32_16x16x32_bf16 a[88:91], a[224:227], v[68:71], 0
    buffer_load_dwordx4 v19, s[20:23], s31 offen nt lds
    v_fma_f32 v214, v214, s32, -v17
    v_mfma_f32_16x16x32_bf16 a[92:95], a[224:227], v[72:75], 0
    s_waitcnt lgkmcnt(10)
    v_exp_f32_e32 v220, v220
    v_fma_f32 v215, v215, s32, -v17
L_s132:
    v_mfma_f32_16x16x32_bf16 a[48:51], a[228:231], v[88:91], a[48:51]
    s_add_u32 s31, s63, 199680
    ds_read_b64_tr_b16 a[224:225], v11 offset:40960
    ds_read_b64_tr_b16 a[226:227], v11 offset:43008
    v_fma_f32 v224, v224, s32, -v17
    v_mfma_f32_16x16x32_bf16 a[52:55], a[228:231], v[92:95], a[52:55]
    v_exp_f32_e64 v221, v221
    v_fma_f32 v225, v225, s32, -v17
    v_mfma_f32_16x16x32_bf16 a[56:59], a[228:231], v[96:99], a[56:59]
    s_waitcnt lgkmcnt(10)
    v_exp_f32_e32 v222, v222
    v_cvt_pk_bf16_f32 v210, v220, v221
L_s133:
    v_mfma_f32_16x16x32_bf16 a[60:63], a[204:207], v[88:91], a[60:63]
    ds_read_b64_tr_b16 a[228:229], v12 offset:40960
    ds_read_b64_tr_b16 a[230:231], v12 offset:43008
    v_fma_f32 v226, v226, s32, -v17
    v_mfma_f32_16x16x32_bf16 a[64:67], a[204:207], v[92:95], a[64:67]
    buffer_load_dwordx4 v19, s[20:23], s31 offen offset:1024 nt lds
    v_fma_f32 v227, v227, s32, -v17
    v_mfma_f32_16x16x32_bf16 a[68:71], a[204:207], v[96:99], a[68:71]
    s_waitcnt lgkmcnt(10)
    v_exp_f32_e32 v223, v223
    v_fma_f32 v216, v216, s32, -v18
L_s134:
    v_mfma_f32_16x16x32_bf16 a[72:75], a[208:211], v[88:91], a[72:75]
    s_add_u32 s31, s63, 210944
    ds_read_b64_tr_b16 a[204:205], v9 offset:45056
    ds_read_b64_tr_b16 a[206:207], v9 offset:47104
    v_cvt_pk_bf16_f32 v211, v222, v223
    v_mfma_f32_16x16x32_bf16 a[76:79], a[208:211], v[92:95], a[76:79]
    v_exp_f32_e64 v212, v212
    v_fma_f32 v217, v217, s32, -v18
    v_mfma_f32_16x16x32_bf16 a[80:83], a[208:211], v[96:99], a[80:83]
    s_waitcnt lgkmcnt(10)
    v_exp_f32_e32 v213, v213
    v_fma_f32 v218, v218, s32, -v18
L_s135:
    v_mfma_f32_16x16x32_bf16 a[84:87], a[212:215], v[88:91], a[84:87]
    ds_read_b64_tr_b16 a[208:209], v10 offset:45056
    ds_read_b64_tr_b16 a[210:211], v10 offset:47104
    v_cvt_pk_bf16_f32 v212, v212, v213
    v_mfma_f32_16x16x32_bf16 a[88:91], a[212:215], v[92:95], a[88:91]
    buffer_load_dwordx4 v19, s[20:23], s31 offen offset:2048 nt lds
    v_fma_f32 v219, v219, s32, -v18
    v_mfma_f32_16x16x32_bf16 a[92:95], a[212:215], v[96:99], a[92:95]
    s_waitcnt lgkmcnt(10)
    v_exp_f32_e32 v214, v214
    v_fma_f32 v228, v228, s32, -v18
L_s136:
    v_mfma_f32_16x16x32_bf16 v[76:79], a[216:219], v[64:67], 0
    s_add_u32 s31, s63, 214016
    ds_read_b64_tr_b16 a[212:213], v11 offset:45056
    ds_read_b64_tr_b16 a[214:215], v11 offset:47104
    v_fma_f32 v229, v229, s32, -v18
    v_mfma_f32_16x16x32_bf16 v[80:83], a[216:219], v[68:71], 0
    v_exp_f32_e64 v215, v215
    v_fma_f32 v230, v230, s32, -v18
    v_mfma_f32_16x16x32_bf16 v[84:87], a[216:219], v[72:75], 0
    s_waitcnt lgkmcnt(10)
    v_exp_f32_e32 v224, v224
    v_cvt_pk_bf16_f32 v213, v214, v215
L_s137:
    v_mfma_f32_16x16x32_bf16 v[100:103], a[220:223], v[64:67], 0
    ds_read_b64_tr_b16 a[216:217], v12 offset:45056
    ds_read_b64_tr_b16 a[218:219], v12 offset:47104
    v_fma_f32 v231, v231, s32, -v18
    v_mfma_f32_16x16x32_bf16 v[104:107], a[220:223], v[68:71], 0
    buffer_load_dwordx4 v19, s[20:23], s31 offen offset:3072 nt lds
    v_fma_f32 v232, v232, s32, -v16
    v_mfma_f32_16x16x32_bf16 v[108:111], a[220:223], v[72:75], 0
    s_waitcnt lgkmcnt(10)
    v_exp_f32_e32 v225, v225
    v_fma_f32 v233, v233, s32, -v16
L_s138:
    v_mfma_f32_16x16x32_bf16 v[124:127], a[224:227], v[64:67], 0
    s_waitcnt vmcnt(12)
    s_barrier
    s_add_u32 m0, s29, 32768
    ds_read_b64_tr_b16 a[220:221], v9 offset:0
    ds_read_b64_tr_b16 a[222:223], v9 offset:2048
    v_mfma_f32_16x16x32_bf16 v[128:131], a[224:227], v[68:71], 0
    s_add_u32 s31, s62, 131072
    v_exp_f32_e64 v226, v226
    v_mfma_f32_16x16x32_bf16 v[132:135], a[224:227], v[72:75], 0
    s_waitcnt lgkmcnt(10)
    v_exp_f32_e32 v227, v227
L_s139:
    v_mfma_f32_16x16x32_bf16 v[148:151], a[228:231], v[64:67], 0
    ds_read_b64_tr_b16 a[224:225], v10 offset:0
    ds_read_b64_tr_b16 a[226:227], v10 offset:2048
    v_mfma_f32_16x16x32_bf16 v[152:155], a[228:231], v[68:71], 0
    ds_write_b96 v53, v[16:18]
    buffer_load_dwordx4 v19, s[20:23], s31 offen nt lds
    v_mfma_f32_16x16x32_bf16 v[156:159], a[228:231], v[72:75], 0
    s_waitcnt lgkmcnt(11)
    v_exp_f32_e32 v216, v216
L_s140:
    v_mfma_f32_16x16x32_bf16 v[76:79], a[204:207], v[88:91], v[76:79]
    s_add_u32 s31, s62, 134144
    ds_read_b64_tr_b16 a[228:229], v11 offset:0
    ds_read_b64_tr_b16 a[230:231], v11 offset:2048
    v_mfma_f32_16x16x32_bf16 v[80:83], a[204:207], v[92:95], v[80:83]
    v_exp_f32_e64 v217, v217
    v_mfma_f32_16x16x32_bf16 v[84:87], a[204:207], v[96:99], v[84:87]
    s_waitcnt lgkmcnt(11)
    v_exp_f32_e32 v218, v218
L_s141:
    v_mfma_f32_16x16x32_bf16 v[100:103], a[208:211], v[88:91], v[100:103]
    ds_read_b64_tr_b16 a[204:205], v12 offset:0
    ds_read_b64_tr_b16 a[206:207], v12 offset:2048
    v_mfma_f32_16x16x32_bf16 v[104:107], a[208:211], v[92:95], v[104:107]
    buffer_load_dwordx4 v19, s[20:23], s31 offen offset:1024 nt lds
    v_mfma_f32_16x16x32_bf16 v[108:111], a[208:211], v[96:99], v[108:111]
    s_waitcnt lgkmcnt(11)
    v_exp_f32_e32 v219, v219
L_s142:
    v_mfma_f32_16x16x32_bf16 v[124:127], a[212:215], v[88:91], v[124:127]
    s_add_u32 s31, s62, 145408
    ds_read_b64_tr_b16 a[208:209], v9 offset:4096
    ds_read_b64_tr_b16 a[210:211], v9 offset:6144
    v_mfma_f32_16x16x32_bf16 v[128:131], a[212:215], v[92:95], v[128:131]
    v_exp_f32_e64 v228, v228
    v_mfma_f32_16x16x32_bf16 v[132:135], a[212:215], v[96:99], v[132:135]
    s_waitcnt lgkmcnt(11)
    v_exp_f32_e32 v229, v229
L_s143:
    v_mfma_f32_16x16x32_bf16 v[148:151], a[216:219], v[88:91], v[148:151]
    ds_read_b64_tr_b16 a[212:213], v10 offset:4096
    ds_read_b64_tr_b16 a[214:215], v10 offset:6144
    v_mfma_f32_16x16x32_bf16 v[152:155], a[216:219], v[92:95], v[152:155]
    buffer_load_dwordx4 v19, s[20:23], s31 offen offset:2048 nt lds
    v_mfma_f32_16x16x32_bf16 v[156:159], a[216:219], v[96:99], v[156:159]
    s_waitcnt lgkmcnt(11)
    v_exp_f32_e32 v230, v230
L_s144:
    v_mfma_f32_16x16x32_bf16 a[48:51], a[220:223], v[112:115], a[48:51]
    s_add_u32 s31, s62, 148480
    ds_read_b64_tr_b16 a[216:217], v11 offset:4096
    ds_read_b64_tr_b16 a[218:219], v11 offset:6144
    v_mfma_f32_16x16x32_bf16 a[52:55], a[220:223], v[116:119], a[52:55]
    v_exp_f32_e64 v231, v231
    v_mfma_f32_16x16x32_bf16 a[56:59], a[220:223], v[120:123], a[56:59]
    s_waitcnt lgkmcnt(11)
    v_exp_f32_e32 v232, v232
L_s145:
    v_mfma_f32_16x16x32_bf16 a[60:63], a[224:227], v[112:115], a[60:63]
    ds_read_b64_tr_b16 a[220:221], v12 offset:4096
    ds_read_b64_tr_b16 a[222:223], v12 offset:6144
    v_mfma_f32_16x16x32_bf16 a[64:67], a[224:227], v[116:119], a[64:67]
    buffer_load_dwordx4 v19, s[20:23], s31 offen offset:3072 nt lds
    v_mfma_f32_16x16x32_bf16 a[68:71], a[224:227], v[120:123], a[68:71]
    s_waitcnt lgkmcnt(10)
    v_exp_f32_e32 v233, v233
L_s146:
    v_mfma_f32_16x16x32_bf16 a[72:75], a[228:231], v[112:115], a[72:75]
    s_waitcnt vmcnt(12) lgkmcnt(12)
    s_barrier
    s_add_u32 m0, s29, 40960
    ds_read_b64_tr_b16 a[224:225], v9 offset:8192
    v_mfma_f32_16x16x32_bf16 a[76:79], a[228:231], v[116:119], a[76:79]
    s_add_u32 s31, s62, 196608
    ds_read_b64_tr_b16 a[226:227], v9 offset:10240
    ds_read_b96 v[40:42], v54
    v_mfma_f32_16x16x32_bf16 a[80:83], a[228:231], v[120:123], a[80:83]
    s_waitcnt lgkmcnt(11)
    v_cvt_pk_bf16_f32 v214, v224, v225
    v_cvt_pk_bf16_f32 v215, v226, v227
L_s147:
    v_mfma_f32_16x16x32_bf16 a[84:87], a[204:207], v[112:115], a[84:87]
    ds_read_b64_tr_b16 a[228:229], v10 offset:8192
    ds_read_b64_tr_b16 a[230:231], v10 offset:10240
    v_mfma_f32_16x16x32_bf16 a[88:91], a[204:207], v[116:119], a[88:91]
    buffer_load_dwordx4 v19, s[20:23], s31 offen nt lds
    v_mfma_f32_16x16x32_bf16 a[92:95], a[204:207], v[120:123], a[92:95]
    s_waitcnt lgkmcnt(11)
    v_cvt_pk_bf16_f32 v216, v216, v217
    v_cvt_pk_bf16_f32 v217, v218, v219
L_s148:
    v_mfma_f32_16x16x32_bf16 a[48:51], a[208:211], v[136:139], a[48:51]
    s_waitcnt lgkmcnt(2)
    s_add_u32 s31, s62, 199680
    ds_read_b64_tr_b16 a[204:205], v11 offset:8192
    v_mfma_f32_16x16x32_bf16 a[52:55], a[208:211], v[140:143], a[52:55]
    ds_read_b64_tr_b16 a[206:207], v11 offset:10240
    v_cvt_pk_bf16_f32 v218, v228, v229
    v_mfma_f32_16x16x32_bf16 a[56:59], a[208:211], v[144:147], a[56:59]
    s_waitcnt lgkmcnt(11)
    v_cvt_pk_bf16_f32 v219, v230, v231
    v_fma_f32 v234, v234, s32, -v16
L_s149:
    v_mfma_f32_16x16x32_bf16 a[60:63], a[212:215], v[136:139], a[60:63]
    ds_read_b64_tr_b16 a[208:209], v12 offset:8192
    ds_read_b64_tr_b16 a[210:211], v12 offset:10240
    v_mfma_f32_16x16x32_bf16 a[64:67], a[212:215], v[140:143], a[64:67]
    buffer_load_dwordx4 v19, s[20:23], s31 offen offset:1024 nt lds
    v_mfma_f32_16x16x32_bf16 a[68:71], a[212:215], v[144:147], a[68:71]
    s_waitcnt lgkmcnt(11)
    v_exp_f32_e32 v234, v234
L_s150:
    v_mfma_f32_16x16x32_bf16 a[72:75], a[216:219], v[136:139], a[72:75]
    s_add_u32 s31, s62, 210944
    ds_read_b64_tr_b16 a[212:213], v9 offset:12288
    v_fma_f32 v235, v235, s32, -v16
    v_mfma_f32_16x16x32_bf16 a[76:79], a[216:219], v[140:143], a[76:79]
    ds_read_b64_tr_b16 a[214:215], v9 offset:14336
    v_fma_f32 v244, v244, s32, -v16
    v_mfma_f32_16x16x32_bf16 a[80:83], a[216:219], v[144:147], a[80:83]
    s_waitcnt lgkmcnt(11)
    v_exp_f32_e32 v235, v235
L_s151:
    v_mfma_f32_16x16x32_bf16 a[84:87], a[220:223], v[136:139], a[84:87]
    ds_read_b64_tr_b16 a[216:217], v10 offset:12288
    ds_read_b64_tr_b16 a[218:219], v10 offset:14336
    v_mfma_f32_16x16x32_bf16 a[88:91], a[220:223], v[140:143], a[88:91]
    buffer_load_dwordx4 v19, s[20:23], s31 offen offset:2048 nt lds
    v_mfma_f32_16x16x32_bf16 a[92:95], a[220:223], v[144:147], a[92:95]
    s_waitcnt lgkmcnt(11)
    v_exp_f32_e32 v244, v244
L_s152:
    v_mfma_f32_16x16x32_bf16 v[76:79], a[224:227], v[112:115], v[76:79]
    s_add_u32 s31, s62, 214016
    ds_read_b64_tr_b16 a[220:221], v11 offset:12288
    v_fma_f32 v245, v245, s32, -v16
    v_mfma_f32_16x16x32_bf16 v[80:83], a[224:227], v[116:119], v[80:83]
    ds_read_b64_tr_b16 a[222:223], v11 offset:14336
    v_fma_f32 v246, v246, s32, -v16
    v_mfma_f32_16x16x32_bf16 v[84:87], a[224:227], v[120:123], v[84:87]
    s_waitcnt lgkmcnt(10)
    v_exp_f32_e32 v245, v245
L_s153:
    v_mfma_f32_16x16x32_bf16 v[100:103], a[228:231], v[112:115], v[100:103]
    ds_read_b64_tr_b16 a[224:225], v12 offset:12288
    ds_read_b64_tr_b16 a[226:227], v12 offset:14336
    v_mfma_f32_16x16x32_bf16 v[104:107], a[228:231], v[116:119], v[104:107]
    buffer_load_dwordx4 v19, s[20:23], s31 offen offset:3072 nt lds
    v_mfma_f32_16x16x32_bf16 v[108:111], a[228:231], v[120:123], v[108:111]
    s_waitcnt lgkmcnt(10)
    v_exp_f32_e32 v246, v246
L_s154:
    v_mfma_f32_16x16x32_bf16 v[124:127], a[204:207], v[112:115], v[124:127]
    s_waitcnt vmcnt(12)
    s_barrier
    s_add_u32 m0, s29, 0
    ds_read_b64_tr_b16 a[228:229], v9 offset:16384
    v_mfma_f32_16x16x32_bf16 v[128:131], a[204:207], v[116:119], v[128:131]
    s_add_u32 s31, s61, 0
    ds_read_b64_tr_b16 a[230:231], v9 offset:18432
    v_fma_f32 v247, v247, s32, -v16
    v_mfma_f32_16x16x32_bf16 v[132:135], a[204:207], v[120:123], v[132:135]
    s_waitcnt lgkmcnt(10)
    v_exp_f32_e32 v247, v247
L_s155:
    v_mfma_f32_16x16x32_bf16 v[148:151], a[208:211], v[112:115], v[148:151]
    ds_read_b64_tr_b16 a[204:205], v10 offset:16384
    ds_read_b64_tr_b16 a[206:207], v10 offset:18432
    v_mfma_f32_16x16x32_bf16 v[152:155], a[208:211], v[116:119], v[152:155]
    buffer_load_dwordx4 v19, s[20:23], s31 offen nt lds
    v_mfma_f32_16x16x32_bf16 v[156:159], a[208:211], v[120:123], v[156:159]
    s_waitcnt lgkmcnt(10)
    v_cvt_pk_bf16_f32 v232, v232, v233
    v_cvt_pk_bf16_f32 v233, v234, v235
L_s156:
    v_mfma_f32_16x16x32_bf16 v[76:79], a[212:215], v[136:139], v[76:79]
    s_add_u32 s31, s61, 3072
    ds_read_b64_tr_b16 a[208:209], v11 offset:16384
    v_cvt_pk_bf16_f32 v234, v244, v245
    v_mfma_f32_16x16x32_bf16 v[80:83], a[212:215], v[140:143], v[80:83]
    ds_read_b64_tr_b16 a[210:211], v11 offset:18432
    v_cvt_pk_bf16_f32 v235, v246, v247
    v_mfma_f32_16x16x32_bf16 v[84:87], a[212:215], v[144:147], v[84:87]
    s_waitcnt lgkmcnt(10)
    v_fma_f32 v236, v236, s32, -v17
    v_fma_f32 v237, v237, s32, -v17
L_s157:
    v_mfma_f32_16x16x32_bf16 v[100:103], a[216:219], v[136:139], v[100:103]
    ds_read_b64_tr_b16 a[212:213], v12 offset:16384
    ds_read_b64_tr_b16 a[214:215], v12 offset:18432
    v_mfma_f32_16x16x32_bf16 v[104:107], a[216:219], v[140:143], v[104:107]
    buffer_load_dwordx4 v19, s[20:23], s31 offen offset:1024 nt lds
    v_mfma_f32_16x16x32_bf16 v[108:111], a[216:219], v[144:147], v[108:111]
    s_waitcnt lgkmcnt(10)
    v_exp_f32_e32 v236, v236
L_s158:
    v_mfma_f32_16x16x32_bf16 v[124:127], a[220:223], v[136:139], v[124:127]
    s_add_u32 s31, s61, 14336
    ds_read_b64_tr_b16 a[216:217], v9 offset:20480
    v_fma_f32 v238, v238, s32, -v17
    v_mfma_f32_16x16x32_bf16 v[128:131], a[220:223], v[140:143], v[128:131]
    ds_read_b64_tr_b16 a[218:219], v9 offset:22528
    v_fma_f32 v239, v239, s32, -v17
    v_mfma_f32_16x16x32_bf16 v[132:135], a[220:223], v[144:147], v[132:135]
    s_waitcnt lgkmcnt(10)
    v_exp_f32_e32 v237, v237
L_s159:
    v_mfma_f32_16x16x32_bf16 v[148:151], a[224:227], v[136:139], v[148:151]
    ds_read_b64_tr_b16 a[220:221], v10 offset:20480
    ds_read_b64_tr_b16 a[222:223], v10 offset:22528
    v_mfma_f32_16x16x32_bf16 v[152:155], a[224:227], v[140:143], v[152:155]
    buffer_load_dwordx4 v19, s[20:23], s31 offen offset:2048 nt lds
    v_mfma_f32_16x16x32_bf16 v[156:159], a[224:227], v[144:147], v[156:159]
    s_waitcnt lgkmcnt(10)
    v_exp_f32_e32 v238, v238
L_s160:
    v_mfma_f32_16x16x32_bf16 a[48:51], a[228:231], v[160:163], a[48:51]
    s_add_u32 s31, s61, 17408
    ds_read_b64_tr_b16 a[224:225], v11 offset:20480
    v_fma_f32 v248, v248, s32, -v17
    v_mfma_f32_16x16x32_bf16 a[52:55], a[228:231], v[164:167], a[52:55]
    ds_read_b64_tr_b16 a[226:227], v11 offset:22528
    v_fma_f32 v249, v249, s32, -v17
    v_mfma_f32_16x16x32_bf16 a[56:59], a[228:231], v[168:171], a[56:59]
    s_waitcnt lgkmcnt(10)
    v_exp_f32_e32 v239, v239
L_s161:
    v_mfma_f32_16x16x32_bf16 a[60:63], a[204:207], v[160:163], a[60:63]
    ds_read_b64_tr_b16 a[228:229], v12 offset:20480
    ds_read_b64_tr_b16 a[230:231], v12 offset:22528
    v_mfma_f32_16x16x32_bf16 a[64:67], a[204:207], v[164:167], a[64:67]
    buffer_load_dwordx4 v19, s[20:23], s31 offen offset:3072 nt lds
    v_mfma_f32_16x16x32_bf16 a[68:71], a[204:207], v[168:171], a[68:71]
    s_waitcnt lgkmcnt(10)
    v_exp_f32_e32 v248, v248
L_s162:
    v_mfma_f32_16x16x32_bf16 a[72:75], a[208:211], v[160:163], a[72:75]
    s_waitcnt vmcnt(12)
    s_barrier
    s_add_u32 m0, s29, 8192
    ds_read_b64_tr_b16 a[204:205], v9 offset:24576
    v_mfma_f32_16x16x32_bf16 a[76:79], a[208:211], v[164:167], a[76:79]
    s_add_u32 s31, s61, 65536
    ds_read_b64_tr_b16 a[206:207], v9 offset:26624
    v_fma_f32 v250, v250, s32, -v17
    v_mfma_f32_16x16x32_bf16 a[80:83], a[208:211], v[168:171], a[80:83]
    s_waitcnt lgkmcnt(10)
    v_exp_f32_e32 v249, v249
L_s163:
    v_mfma_f32_16x16x32_bf16 a[84:87], a[212:215], v[160:163], a[84:87]
    ds_read_b64_tr_b16 a[208:209], v10 offset:24576
    ds_read_b64_tr_b16 a[210:211], v10 offset:26624
    v_mfma_f32_16x16x32_bf16 a[88:91], a[212:215], v[164:167], a[88:91]
    buffer_load_dwordx4 v19, s[20:23], s31 offen nt lds
    v_mfma_f32_16x16x32_bf16 a[92:95], a[212:215], v[168:171], a[92:95]
    s_waitcnt lgkmcnt(10)
    v_exp_f32_e32 v250, v250
L_s164:
    v_mfma_f32_16x16x32_bf16 a[48:51], a[216:219], v[184:187], a[48:51]
    s_add_u32 s31, s61, 68608
    ds_read_b64_tr_b16 a[212:213], v11 offset:24576
    v_fma_f32 v251, v251, s32, -v17
    v_mfma_f32_16x16x32_bf16 a[52:55], a[216:219], v[188:191], a[52:55]
    ds_read_b64_tr_b16 a[214:215], v11 offset:26624
    v_cvt_pk_bf16_f32 v236, v236, v237
    v_mfma_f32_16x16x32_bf16 a[56:59], a[216:219], v[192:195], a[56:59]
    v_exp_f32_e64 v251, v251
    v_mfma_f32_16x16x32_bf16 a[192:195], v[20:23], v[184:187], a[192:195]
    s_waitcnt lgkmcnt(10)
    v_cvt_pk_bf16_f32 v237, v238, v239
    v_cvt_pk_bf16_f32 v238, v248, v249
L_s165:
    v_mfma_f32_16x16x32_bf16 a[60:63], a[220:223], v[184:187], a[60:63]
    ds_read_b64_tr_b16 a[216:217], v12 offset:24576
    ds_read_b64_tr_b16 a[218:219], v12 offset:26624
    v_mfma_f32_16x16x32_bf16 a[64:67], a[220:223], v[188:191], a[64:67]
    buffer_load_dwordx4 v19, s[20:23], s31 offen offset:1024 nt lds
    v_mfma_f32_16x16x32_bf16 a[68:71], a[220:223], v[192:195], a[68:71]
    v_cvt_pk_bf16_f32 v239, v250, v251
    v_fma_f32 v240, v240, s32, -v18
    v_mfma_f32_16x16x32_bf16 a[196:199], v[20:23], v[188:191], a[196:199]
    s_waitcnt lgkmcnt(10)
    v_exp_f32_e64 v240, v240
L_s166:
    v_mfma_f32_16x16x32_bf16 a[72:75], a[224:227], v[184:187], a[72:75]
    s_add_u32 s31, s61, 79872
    ds_read_b64_tr_b16 a[220:221], v9 offset:28672
    v_fma_f32 v241, v241, s32, -v18
    v_mfma_f32_16x16x32_bf16 a[76:79], a[224:227], v[188:191], a[76:79]
    ds_read_b64_tr_b16 a[222:223], v9 offset:30720
    v_fma_f32 v242, v242, s32, -v18
    v_mfma_f32_16x16x32_bf16 a[80:83], a[224:227], v[192:195], a[80:83]
    v_exp_f32_e64 v241, v241
    v_mfma_f32_16x16x32_bf16 a[200:203], v[20:23], v[192:195], a[200:203]
    s_waitcnt lgkmcnt(10)
    v_exp_f32_e32 v242, v242
L_s167:
    v_mfma_f32_16x16x32_bf16 a[84:87], a[228:231], v[184:187], a[84:87]
    ds_read_b64_tr_b16 a[224:225], v10 offset:28672
    ds_read_b64_tr_b16 a[226:227], v10 offset:30720
    v_mfma_f32_16x16x32_bf16 a[88:91], a[228:231], v[188:191], a[88:91]
    buffer_load_dwordx4 v19, s[20:23], s31 offen offset:2048 nt lds
    v_mfma_f32_16x16x32_bf16 a[92:95], a[228:231], v[192:195], a[92:95]
    s_waitcnt lgkmcnt(10)
    v_fma_f32 v243, v243, s32, -v18
    v_fma_f32 v252, v252, s32, -v18
L_s168:
    v_mfma_f32_16x16x32_bf16 a[48:51], a[204:207], v[208:211], a[48:51]
    s_add_u32 s31, s61, 82944
    ds_read_b64_tr_b16 a[228:229], v11 offset:28672
    ds_read_b64_tr_b16 a[230:231], v11 offset:30720
    v_mfma_f32_16x16x32_bf16 a[52:55], a[204:207], v[212:215], a[52:55]
    v_exp_f32_e32 v243, v243
    v_mfma_f32_16x16x32_bf16 a[56:59], a[204:207], v[216:219], a[56:59]
    v_exp_f32_e64 v252, v252
    v_mfma_f32_16x16x32_bf16 a[192:195], v[20:23], v[208:211], a[192:195]
    s_waitcnt lgkmcnt(10)
    v_fma_f32 v253, v253, s32, -v18
    v_fma_f32 v254, v254, s32, -v18
L_s169:
    v_mfma_f32_16x16x32_bf16 a[60:63], a[208:211], v[208:211], a[60:63]
    ds_read_b64_tr_b16 a[204:205], v12 offset:28672
    ds_read_b64_tr_b16 a[206:207], v12 offset:30720
    v_mfma_f32_16x16x32_bf16 a[64:67], a[208:211], v[212:215], a[64:67]
    buffer_load_dwordx4 v19, s[20:23], s31 offen offset:3072 nt lds
    v_mfma_f32_16x16x32_bf16 a[68:71], a[208:211], v[216:219], a[68:71]
    v_exp_f32_e32 v253, v253
    v_mfma_f32_16x16x32_bf16 a[196:199], v[20:23], v[212:215], a[196:199]
    s_waitcnt lgkmcnt(10)
    v_exp_f32_e32 v254, v254
L_s170:
    v_mfma_f32_16x16x32_bf16 a[72:75], a[212:215], v[208:211], a[72:75]
    s_waitcnt vmcnt(12)
    s_barrier
    s_add_u32 m0, s29, 16384
    ds_read_b64_tr_b16 a[208:209], v9 offset:32768
    v_mfma_f32_16x16x32_bf16 a[76:79], a[212:215], v[212:215], a[76:79]
    s_add_u32 s31, s61, 131072
    ds_read_b64_tr_b16 a[210:211], v9 offset:34816
    v_fma_f32 v255, v255, s32, -v18
    v_mfma_f32_16x16x32_bf16 a[80:83], a[212:215], v[216:219], a[80:83]
    v_exp_f32_e64 v255, v255
    v_mfma_f32_16x16x32_bf16 a[200:203], v[20:23], v[216:219], a[200:203]
    s_waitcnt lgkmcnt(10)
    v_cvt_pk_bf16_f32 v240, v240, v241
    v_cvt_pk_bf16_f32 v241, v242, v243
L_s171:
    v_mfma_f32_16x16x32_bf16 a[84:87], a[216:219], v[208:211], a[84:87]
    ds_read_b64_tr_b16 a[212:213], v10 offset:32768
    ds_read_b64_tr_b16 a[214:215], v10 offset:34816
    v_mfma_f32_16x16x32_bf16 a[88:91], a[216:219], v[212:215], a[88:91]
    buffer_load_dwordx4 v19, s[20:23], s31 offen nt lds
    v_mfma_f32_16x16x32_bf16 a[92:95], a[216:219], v[216:219], a[92:95]
    s_waitcnt lgkmcnt(10)
    v_cvt_pk_bf16_f32 v242, v252, v253
    v_cvt_pk_bf16_f32 v243, v254, v255
L_s172:
    v_mfma_f32_16x16x32_bf16 a[48:51], a[220:223], v[232:235], a[48:51]
    s_add_u32 s31, s61, 134144
    ds_read_b64_tr_b16 a[216:217], v11 offset:32768
    v_max_f32_e64 v28, v16, v40
    v_mfma_f32_16x16x32_bf16 a[52:55], a[220:223], v[236:239], a[52:55]
    ds_read_b64_tr_b16 a[218:219], v11 offset:34816
    v_sub_f32_e64 v48, v16, v28
    v_mfma_f32_16x16x32_bf16 a[56:59], a[220:223], v[240:243], a[56:59]
    v_exp_f32_e64 v48, v48
    v_mfma_f32_16x16x32_bf16 a[192:195], v[20:23], v[232:235], a[192:195]
    s_waitcnt lgkmcnt(10)
    v_sub_f32_e32 v49, v40, v28
    v_max_f32_e64 v29, v17, v41
L_s173:
    v_mfma_f32_16x16x32_bf16 a[60:63], a[224:227], v[232:235], a[60:63]
    ds_read_b64_tr_b16 a[220:221], v12 offset:32768
    ds_read_b64_tr_b16 a[222:223], v12 offset:34816
    v_mfma_f32_16x16x32_bf16 a[64:67], a[224:227], v[236:239], a[64:67]
    buffer_load_dwordx4 v19, s[20:23], s31 offen offset:1024 nt lds
    v_mfma_f32_16x16x32_bf16 a[68:71], a[224:227], v[240:243], a[68:71]
    v_exp_f32_e64 v49, v49
    v_mfma_f32_16x16x32_bf16 a[196:199], v[20:23], v[236:239], a[196:199]
    s_waitcnt lgkmcnt(10)
    v_sub_f32_e32 v50, v17, v29
    v_sub_f32_e64 v51, v41, v29
L_s174:
    v_mfma_f32_16x16x32_bf16 a[72:75], a[228:231], v[232:235], a[72:75]
    s_add_u32 s31, s61, 145408
    ds_read_b64_tr_b16 a[224:225], v9 offset:36864
    ds_read_b64_tr_b16 a[226:227], v9 offset:38912
    v_mfma_f32_16x16x32_bf16 a[76:79], a[228:231], v[236:239], a[76:79]
    v_exp_f32_e64 v50, v50
    v_mfma_f32_16x16x32_bf16 a[80:83], a[228:231], v[240:243], a[80:83]
    v_exp_f32_e64 v51, v51
    v_mfma_f32_16x16x32_bf16 a[200:203], v[20:23], v[240:243], a[200:203]
    s_waitcnt lgkmcnt(10)
    v_max_f32_e32 v30, v18, v42
    v_sub_f32_e64 v60, v18, v30
L_s175:
    v_mfma_f32_16x16x32_bf16 a[84:87], a[204:207], v[232:235], a[84:87]
    ds_read_b64_tr_b16 a[228:229], v10 offset:36864
    ds_read_b64_tr_b16 a[230:231], v10 offset:38912
    v_mfma_f32_16x16x32_bf16 a[88:91], a[204:207], v[236:239], a[88:91]
    ds_write_b128 v55, a[48:51] offset:0
    buffer_load_dwordx4 v19, s[20:23], s31 offen offset:2048 nt lds
    v_mfma_f32_16x16x32_bf16 a[92:95], a[204:207], v[240:243], a[92:95]
    s_waitcnt lgkmcnt(11)
    v_exp_f32_e32 v60, v60
L_s176:
    v_mfma_f32_16x16x32_bf16 v[76:79], a[208:211], v[160:163], v[76:79]
    s_add_u32 s31, s61, 148480
    ds_read_b64_tr_b16 a[204:205], v11 offset:36864
    v_sub_f32_e64 v61, v42, v30
    v_mfma_f32_16x16x32_bf16 v[80:83], a[208:211], v[164:167], v[80:83]
    ds_read_b64_tr_b16 a[206:207], v11 offset:38912
    ds_write_b128 v55, a[52:55] offset:1024
    v_mfma_f32_16x16x32_bf16 v[84:87], a[208:211], v[168:171], v[84:87]
    s_waitcnt lgkmcnt(12)
    v_exp_f32_e32 v61, v61
L_s177:
    v_mfma_f32_16x16x32_bf16 v[100:103], a[212:215], v[160:163], v[100:103]
    ds_read_b64_tr_b16 a[208:209], v12 offset:36864
    ds_read_b64_tr_b16 a[210:211], v12 offset:38912
    v_mfma_f32_16x16x32_bf16 v[104:107], a[212:215], v[164:167], v[104:107]
    ds_write_b128 v55, a[56:59] offset:2048
    buffer_load_dwordx4 v19, s[20:23], s31 offen offset:3072 nt lds
    v_mfma_f32_16x16x32_bf16 v[108:111], a[212:215], v[168:171], v[108:111]
    s_waitcnt lgkmcnt(13)
L_s178:
    v_mfma_f32_16x16x32_bf16 v[124:127], a[216:219], v[160:163], v[124:127]
    s_waitcnt vmcnt(12)
    s_barrier
    s_add_u32 m0, s29, 24576
    ds_read_b64_tr_b16 a[212:213], v9 offset:40960
    ds_read_b64_tr_b16 a[214:215], v9 offset:43008
    v_mfma_f32_16x16x32_bf16 v[128:131], a[216:219], v[164:167], v[128:131]
    s_add_u32 s31, s61, 196608
    ds_write_b128 v55, a[60:63] offset:3072
    v_mfma_f32_16x16x32_bf16 v[132:135], a[216:219], v[168:171], v[132:135]
    s_waitcnt lgkmcnt(14)
    v_cmp_eq_u32 vcc, 0, v24
    s_cbranch_vccnz L_nonce
L_havenonce:
L_s179:
    v_mfma_f32_16x16x32_bf16 v[148:151], a[220:223], v[160:163], v[148:151]
    ds_read_b64_tr_b16 a[216:217], v10 offset:40960
    ds_read_b64_tr_b16 a[218:219], v10 offset:43008
    v_mfma_f32_16x16x32_bf16 v[152:155], a[220:223], v[164:167], v[152:155]
    ds_write_b128 v55, a[64:67] offset:4096
    buffer_load_dwordx4 v19, s[20:23], s31 offen nt lds
    v_mfma_f32_16x16x32_bf16 v[156:159], a[220:223], v[168:171], v[156:159]
    s_waitcnt lgkmcnt(15)
L_s180:
    v_mfma_f32_16x16x32_bf16 v[76:79], a[224:227], v[184:187], v[76:79]
    s_add_u32 s31, s61, 199680
    ds_read_b64_tr_b16 a[220:221], v11 offset:40960
    v_accvgpr_read_b32 v32, a192
    v_mul_f32_e32 v32, v32, v48
    v_mfma_f32_16x16x32_bf16 v[80:83], a[224:227], v[188:191], v[80:83]
    ds_read_b64_tr_b16 a[222:223], v11 offset:43008
    ds_write_b128 v55, a[68:71] offset:5120
    v_accvgpr_read_b32 v33, a196
    v_mfma_f32_16x16x32_bf16 v[84:87], a[224:227], v[192:195], v[84:87]
    s_waitcnt lgkmcnt(15)
    ds_write_b32 v53, a192 offset:256
    v_mul_f32_e32 v33, v33, v50
    v_accvgpr_read_b32 v34, a200
L_s181:
    v_mfma_f32_16x16x32_bf16 v[100:103], a[228:231], v[184:187], v[100:103]
    ds_read_b64_tr_b16 a[224:225], v12 offset:40960
    ds_read_b64_tr_b16 a[226:227], v12 offset:43008
    v_mul_f32_e64 v34, v34, v60
    v_mfma_f32_16x16x32_bf16 v[104:107], a[228:231], v[188:191], v[104:107]
    ds_write_b128 v55, a[72:75] offset:6144
    buffer_load_dwordx4 v19, s[20:23], s31 offen offset:1024 nt lds
    v_mfma_f32_16x16x32_bf16 v[108:111], a[228:231], v[192:195], v[108:111]
    s_waitcnt lgkmcnt(15)
    ds_write_b32 v53, a196 offset:260
L_s182:
    v_mfma_f32_16x16x32_bf16 v[124:127], a[204:207], v[184:187], v[124:127]
    s_add_u32 s31, s61, 210944
    ds_read_b64_tr_b16 a[228:229], v9 offset:45056
    v_mov_b32_e32 v31, v24
    v_xor_b32_e64 v35, s10, v24
    v_mfma_f32_16x16x32_bf16 v[128:131], a[204:207], v[188:191], v[128:131]
    ds_read_b64_tr_b16 a[230:231], v9 offset:47104
    ds_write_b128 v55, a[76:79] offset:7168
    v_mfma_f32_16x16x32_bf16 v[132:135], a[204:207], v[192:195], v[132:135]
    s_waitcnt lgkmcnt(15)
    ds_write_b32 v53, a200 offset:264
L_s183:
    v_mfma_f32_16x16x32_bf16 v[148:151], a[208:211], v[184:187], v[148:151]
    ds_read_b64_tr_b16 a[204:205], v10 offset:45056
    ds_read_b64_tr_b16 a[206:207], v10 offset:47104
    v_mfma_f32_16x16x32_bf16 v[152:155], a[208:211], v[188:191], v[152:155]
    ds_write_b128 v55, a[80:83] offset:8192
    buffer_load_dwordx4 v19, s[20:23], s31 offen offset:2048 nt lds
    v_mfma_f32_16x16x32_bf16 v[156:159], a[208:211], v[192:195], v[156:159]
    s_waitcnt lgkmcnt(15)
L_s184:
    v_mfma_f32_16x16x32_bf16 v[76:79], a[212:215], v[208:211], v[76:79]
    s_add_u32 s31, s61, 214016
    ds_read_b64_tr_b16 a[208:209], v11 offset:45056
    ds_read_b64_tr_b16 a[210:211], v11 offset:47104
    v_mfma_f32_16x16x32_bf16 v[80:83], a[212:215], v[212:215], v[80:83]
    ds_write_b128 v55, a[84:87] offset:9216
    v_mfma_f32_16x16x32_bf16 v[84:87], a[212:215], v[216:219], v[84:87]
    s_waitcnt lgkmcnt(15)
L_s185:
    v_mfma_f32_16x16x32_bf16 v[100:103], a[216:219], v[208:211], v[100:103]
    ds_read_b64_tr_b16 a[212:213], v12 offset:45056
    ds_read_b64_tr_b16 a[214:215], v12 offset:47104
    v_mfma_f32_16x16x32_bf16 v[104:107], a[216:219], v[212:215], v[104:107]
    ds_write_b128 v55, a[88:91] offset:10240
    buffer_load_dwordx4 v19, s[20:23], s31 offen offset:3072 nt lds
    v_mfma_f32_16x16x32_bf16 v[108:111], a[216:219], v[216:219], v[108:111]
    s_waitcnt lgkmcnt(15)
    ds_write_b128 v55, a[92:95] offset:11264
L_s186:
    v_mfma_f32_16x16x32_bf16 v[124:127], a[220:223], v[208:211], v[124:127]
    s_waitcnt vmcnt(12) lgkmcnt(0)
    s_barrier
    s_add_u32 m0, s29, 32768
    ds_read_b64_tr_b16 a[216:217], v9 offset:0
    ds_read_b64_tr_b16 a[218:219], v9 offset:2048
    v_mfma_f32_16x16x32_bf16 v[128:131], a[220:223], v[212:215], v[128:131]
    s_add_u32 s31, s60, 0
    ds_read_b96 v[36:38], v54 offset:256
    v_mfma_f32_16x16x32_bf16 v[132:135], a[220:223], v[216:219], v[132:135]
    s_waitcnt lgkmcnt(15)
    ds_read_b128 v[172:175], v56 offset:0
L_s187:
    v_mfma_f32_16x16x32_bf16 v[148:151], a[224:227], v[208:211], v[148:151]
    ds_read_b64_tr_b16 a[220:221], v10 offset:0
    ds_read_b64_tr_b16 a[222:223], v10 offset:2048
    v_mfma_f32_16x16x32_bf16 v[152:155], a[224:227], v[212:215], v[152:155]
    ds_read_b128 v[196:199], v56 offset:3072
    buffer_load_dwordx4 v19, s[20:23], s31 offen nt lds
    v_mfma_f32_16x16x32_bf16 v[156:159], a[224:227], v[216:219], v[156:159]
    s_waitcnt lgkmcnt(15)
    ds_read_b128 v[220:223], v56 offset:6144
L_s188:
    v_mfma_f32_16x16x32_bf16 v[76:79], a[228:231], v[232:235], v[76:79]
    s_add_u32 s31, s60, 3072
    ds_read_b64_tr_b16 a[224:225], v11 offset:0
    ds_read_b64_tr_b16 a[226:227], v11 offset:2048
    v_mfma_f32_16x16x32_bf16 v[80:83], a[228:231], v[236:239], v[80:83]
    ds_read_b128 v[244:247], v56 offset:9216
    v_mfma_f32_16x16x32_bf16 v[84:87], a[228:231], v[240:243], v[84:87]
    s_waitcnt lgkmcnt(15)
    ds_read_b128 v[176:179], v56 offset:1024
L_s189:
    v_mfma_f32_16x16x32_bf16 v[100:103], a[204:207], v[232:235], v[100:103]
    ds_read_b64_tr_b16 a[228:229], v12 offset:0
    ds_read_b64_tr_b16 a[230:231], v12 offset:2048
    v_mfma_f32_16x16x32_bf16 v[104:107], a[204:207], v[236:239], v[104:107]
    ds_read_b128 v[200:203], v56 offset:4096
    buffer_load_dwordx4 v19, s[20:23], s31 offen offset:1024 nt lds
    v_mfma_f32_16x16x32_bf16 v[108:111], a[204:207], v[240:243], v[108:111]
    s_waitcnt lgkmcnt(15)
    ds_read_b128 v[224:227], v56 offset:7168
L_s190:
    v_mfma_f32_16x16x32_bf16 v[124:127], a[208:211], v[232:235], v[124:127]
    s_waitcnt lgkmcnt(1)
    s_add_u32 s31, s60, 14336
    ds_read_b64_tr_b16 a[204:205], v9 offset:4096
    v_mul_f32_e64 v172, v172, v49
    v_mul_f32_e64 v173, v173, v49
    v_mul_f32_e64 v174, v174, v49
    v_mfma_f32_16x16x32_bf16 v[128:131], a[208:211], v[236:239], v[128:131]
    ds_read_b64_tr_b16 a[206:207], v9 offset:6144
    ds_read_b128 v[248:251], v56 offset:10240
    v_mul_f32_e64 v175, v175, v49
    v_mul_f32_e64 v196, v196, v49
    v_mul_f32_e64 v197, v197, v49
    v_mfma_f32_16x16x32_bf16 v[132:135], a[208:211], v[240:243], v[132:135]
    s_waitcnt lgkmcnt(15)
    ds_read_b128 v[180:183], v56 offset:2048
    v_mul_f32_e32 v198, v198, v49
    v_mul_f32_e64 v199, v199, v49
    v_mul_f32_e64 v220, v220, v49
    v_mul_f32_e64 v221, v221, v49
L_s191:
    v_mfma_f32_16x16x32_bf16 v[148:151], a[212:215], v[232:235], v[148:151]
    ds_read_b64_tr_b16 a[208:209], v10 offset:4096
    ds_read_b64_tr_b16 a[210:211], v10 offset:6144
    v_mul_f32_e64 v222, v222, v49
    v_mul_f32_e64 v223, v223, v49
    v_mul_f32_e64 v244, v244, v49
    v_mfma_f32_16x16x32_bf16 v[152:155], a[212:215], v[236:239], v[152:155]
    ds_read_b128 v[204:207], v56 offset:5120
    buffer_load_dwordx4 v19, s[20:23], s31 offen offset:2048 nt lds
    v_mul_f32_e64 v245, v245, v49
    v_mul_f32_e64 v246, v246, v49
    v_mul_f32_e64 v247, v247, v49
    v_mfma_f32_16x16x32_bf16 v[156:159], a[212:215], v[240:243], v[156:159]
    s_waitcnt lgkmcnt(15)
    ds_read_b128 v[228:231], v56 offset:8192
    v_mul_f32_e32 v176, v176, v51
    v_mul_f32_e64 v177, v177, v51
    v_mul_f32_e64 v178, v178, v51
    v_mul_f32_e64 v179, v179, v51
L_s192:
    v_mfma_f32_16x16x32_bf16 a[0:3], a[216:219], v[64:67], 0
    s_add_u32 s31, s60, 17408
    ds_read_b64_tr_b16 a[212:213], v11 offset:4096
    v_fma_f32 v76, v76, v48, v172
    v_fma_f32 v77, v77, v48, v173
    v_fma_f32 v78, v78, v48, v174
    v_fma_f32 v79, v79, v48, v175
    v_mfma_f32_16x16x32_bf16 a[4:7], a[216:219], v[68:71], 0
    ds_read_b64_tr_b16 a[214:215], v11 offset:6144
    ds_read_b128 v[252:255], v56 offset:11264
    v_fma_f32 v100, v100, v48, v196
    v_fma_f32 v101, v101, v48, v197
    v_fma_f32 v102, v102, v48, v198
    v_mfma_f32_16x16x32_bf16 a[8:11], a[216:219], v[72:75], 0
    s_waitcnt lgkmcnt(15)
    v_fma_f32 v103, v103, v48, v199
    v_cvt_pk_bf16_f32 v172, v76, v77
    v_cvt_pk_bf16_f32 v173, v78, v79
    v_cvt_pk_bf16_f32 v174, v100, v101
    v_cvt_pk_bf16_f32 v175, v102, v103
L_s193:
    v_mfma_f32_16x16x32_bf16 a[12:15], a[220:223], v[64:67], 0
    ds_read_b64_tr_b16 a[216:217], v12 offset:4096
    ds_read_b64_tr_b16 a[218:219], v12 offset:6144
    v_fma_f32 v124, v124, v48, v220
    v_fma_f32 v125, v125, v48, v221
    v_fma_f32 v126, v126, v48, v222
    v_mfma_f32_16x16x32_bf16 a[16:19], a[220:223], v[68:71], 0
    buffer_load_dwordx4 v19, s[20:23], s31 offen offset:3072 nt lds
    v_fma_f32 v127, v127, v48, v223
    v_fma_f32 v148, v148, v48, v244
    v_fma_f32 v149, v149, v48, v245
    v_mfma_f32_16x16x32_bf16 a[20:23], a[220:223], v[72:75], 0
    s_waitcnt lgkmcnt(15)
    s_add_u32 s43, s45, 0
    buffer_store_dwordx4 v[172:175], v59, s[24:27], s43 offen
    v_fma_f32 v150, v150, v48, v246
    v_fma_f32 v151, v151, v48, v247
    v_cvt_pk_bf16_f32 v220, v124, v125
L_s194:
    v_mfma_f32_16x16x32_bf16 a[24:27], a[224:227], v[64:67], 0
    s_waitcnt lgkmcnt(2)
    s_waitcnt vmcnt(13)
    s_barrier
    s_add_u32 m0, s29, 40960
    ds_read_b64_tr_b16 a[220:221], v9 offset:8192
    v_cvt_pk_bf16_f32 v221, v126, v127
    v_cvt_pk_bf16_f32 v222, v148, v149
    v_cvt_pk_bf16_f32 v223, v150, v151
    v_mfma_f32_16x16x32_bf16 a[28:31], a[224:227], v[68:71], 0
    s_add_u32 s31, s60, 65536
    ds_read_b64_tr_b16 a[222:223], v9 offset:10240
    s_add_u32 s43, s45, 4096
    buffer_store_dwordx4 v[220:223], v59, s[24:27], s43 offen
    v_fma_f32 v80, v80, v50, v176
    v_fma_f32 v81, v81, v50, v177
    v_fma_f32 v82, v82, v50, v178
    v_mfma_f32_16x16x32_bf16 a[32:35], a[224:227], v[72:75], 0
    s_waitcnt lgkmcnt(15)
    v_fma_f32 v83, v83, v50, v179
    v_mul_f32_e32 v200, v200, v51
    v_fma_f32 v104, v104, v50, v200
    v_mul_f32_e64 v201, v201, v51
    v_fma_f32 v105, v105, v50, v201
L_s195:
    v_mfma_f32_16x16x32_bf16 a[36:39], a[228:231], v[64:67], 0
    ds_read_b64_tr_b16 a[224:225], v10 offset:8192
    ds_read_b64_tr_b16 a[226:227], v10 offset:10240
    v_mul_f32_e64 v202, v202, v51
    v_fma_f32 v106, v106, v50, v202
    v_mul_f32_e64 v203, v203, v51
    v_mfma_f32_16x16x32_bf16 a[40:43], a[228:231], v[68:71], 0
    buffer_load_dwordx4 v19, s[20:23], s31 offen nt lds
    v_fma_f32 v107, v107, v50, v203
    v_cvt_pk_bf16_f32 v176, v80, v81
    v_cvt_pk_bf16_f32 v177, v82, v83
    v_mfma_f32_16x16x32_bf16 a[44:47], a[228:231], v[72:75], 0
    s_waitcnt lgkmcnt(15)
    v_cvt_pk_bf16_f32 v178, v104, v105
    v_cvt_pk_bf16_f32 v179, v106, v107
    v_mul_f32_e32 v224, v224, v51
    v_fma_f32 v128, v128, v50, v224
    v_mul_f32_e64 v225, v225, v51
L_s196:
    v_mfma_f32_16x16x32_bf16 a[0:3], a[204:207], v[88:91], a[0:3]
    s_add_u32 s31, s60, 68608
    ds_read_b64_tr_b16 a[228:229], v11 offset:8192
    ds_read_b64_tr_b16 a[230:231], v11 offset:10240
    v_fma_f32 v129, v129, v50, v225
    v_mul_f32_e64 v226, v226, v51
    v_fma_f32 v130, v130, v50, v226
    v_mfma_f32_16x16x32_bf16 a[4:7], a[204:207], v[92:95], a[4:7]
    s_add_u32 s43, s45, 8192
    buffer_store_dwordx4 v[176:179], v59, s[24:27], s43 offen
    v_mul_f32_e64 v227, v227, v51
    v_fma_f32 v131, v131, v50, v227
    v_mul_f32_e64 v248, v248, v51
    v_mfma_f32_16x16x32_bf16 a[8:11], a[204:207], v[96:99], a[8:11]
    s_waitcnt lgkmcnt(13)
    v_fma_f32 v152, v152, v50, v248
    v_mul_f32_e32 v249, v249, v51
    v_fma_f32 v153, v153, v50, v249
    v_mul_f32_e64 v250, v250, v51
    v_fma_f32 v154, v154, v50, v250
L_s197:
    v_mfma_f32_16x16x32_bf16 a[12:15], a[208:211], v[88:91], a[12:15]
    ds_read_b64_tr_b16 a[204:205], v12 offset:8192
    ds_read_b64_tr_b16 a[206:207], v12 offset:10240
    v_mul_f32_e64 v251, v251, v51
    v_fma_f32 v155, v155, v50, v251
    v_cvt_pk_bf16_f32 v224, v128, v129
    v_mfma_f32_16x16x32_bf16 a[16:19], a[208:211], v[92:95], a[16:19]
    buffer_load_dwordx4 v19, s[20:23], s31 offen offset:1024 nt lds
    v_cvt_pk_bf16_f32 v225, v130, v131
    v_cvt_pk_bf16_f32 v226, v152, v153
    v_cvt_pk_bf16_f32 v227, v154, v155
    v_mfma_f32_16x16x32_bf16 a[20:23], a[208:211], v[96:99], a[20:23]
    s_waitcnt lgkmcnt(11)
    s_add_u32 s43, s45, 12288
    buffer_store_dwordx4 v[224:227], v59, s[24:27], s43 offen
    v_mul_f32_e32 v180, v180, v61
    v_fma_f32 v84, v84, v60, v180
    v_mul_f32_e64 v181, v181, v61
L_s198:
    v_mfma_f32_16x16x32_bf16 a[24:27], a[212:215], v[88:91], a[24:27]
    s_add_u32 s31, s60, 79872
    ds_read_b64_tr_b16 a[208:209], v9 offset:12288
    v_fma_f32 v85, v85, v60, v181
    v_mul_f32_e64 v182, v182, v61
    v_fma_f32 v86, v86, v60, v182
    v_mul_f32_e64 v183, v183, v61
    v_mfma_f32_16x16x32_bf16 a[28:31], a[212:215], v[92:95], a[28:31]
    ds_read_b64_tr_b16 a[210:211], v9 offset:14336
    v_fma_f32 v87, v87, v60, v183
    v_mul_f32_e64 v204, v204, v61
    v_fma_f32 v108, v108, v60, v204
    v_mul_f32_e64 v205, v205, v61
    v_mfma_f32_16x16x32_bf16 a[32:35], a[212:215], v[96:99], a[32:35]
    s_waitcnt lgkmcnt(10)
    v_fma_f32 v109, v109, v60, v205
    v_mul_f32_e32 v206, v206, v61
    v_fma_f32 v110, v110, v60, v206
    v_mul_f32_e64 v207, v207, v61
    v_fma_f32 v111, v111, v60, v207
L_s199:
    v_mfma_f32_16x16x32_bf16 a[36:39], a[216:219], v[88:91], a[36:39]
    ds_read_b64_tr_b16 a[212:213], v10 offset:12288
    ds_read_b64_tr_b16 a[214:215], v10 offset:14336
    v_cvt_pk_bf16_f32 v180, v84, v85
    v_cvt_pk_bf16_f32 v181, v86, v87
    v_cvt_pk_bf16_f32 v182, v108, v109
    v_mfma_f32_16x16x32_bf16 a[40:43], a[216:219], v[92:95], a[40:43]
    buffer_load_dwordx4 v19, s[20:23], s31 offen offset:2048 nt lds
    v_cvt_pk_bf16_f32 v183, v110, v111
    v_mul_f32_e64 v228, v228, v61
    v_fma_f32 v132, v132, v60, v228
    v_mfma_f32_16x16x32_bf16 a[44:47], a[216:219], v[96:99], a[44:47]
    s_waitcnt lgkmcnt(10)
    s_add_u32 s43, s45, 16384
    buffer_store_dwordx4 v[180:183], v59, s[24:27], s43 offen
    v_mul_f32_e32 v229, v229, v61
    v_fma_f32 v133, v133, v60, v229
    v_mul_f32_e64 v230, v230, v61
L_s200:
    v_mfma_f32_16x16x32_bf16 a[0:3], a[220:223], v[112:115], a[0:3]
    s_add_u32 s31, s60, 82944
    ds_read_b64_tr_b16 a[216:217], v11 offset:12288
    v_fma_f32 v134, v134, v60, v230
    v_mul_f32_e64 v231, v231, v61
    v_fma_f32 v135, v135, v60, v231
    v_mfma_f32_16x16x32_bf16 a[4:7], a[220:223], v[116:119], a[4:7]
    ds_read_b64_tr_b16 a[218:219], v11 offset:14336
    v_mul_f32_e64 v252, v252, v61
    v_fma_f32 v156, v156, v60, v252
    v_mul_f32_e64 v253, v253, v61
    v_fma_f32 v157, v157, v60, v253
    v_mfma_f32_16x16x32_bf16 a[8:11], a[220:223], v[120:123], a[8:11]
    s_waitcnt lgkmcnt(10)
    v_mul_f32_e32 v254, v254, v61
    v_fma_f32 v158, v158, v60, v254
    v_mul_f32_e64 v255, v255, v61
    v_fma_f32 v159, v159, v60, v255
L_s201:
    v_mfma_f32_16x16x32_bf16 a[12:15], a[224:227], v[112:115], a[12:15]
    ds_read_b64_tr_b16 a[220:221], v12 offset:12288
    ds_read_b64_tr_b16 a[222:223], v12 offset:14336
    v_cvt_pk_bf16_f32 v228, v132, v133
    v_mfma_f32_16x16x32_bf16 a[16:19], a[224:227], v[116:119], a[16:19]
    buffer_load_dwordx4 v19, s[20:23], s31 offen offset:3072 nt lds
    v_cvt_pk_bf16_f32 v229, v134, v135
    v_cvt_pk_bf16_f32 v230, v156, v157
    v_cvt_pk_bf16_f32 v231, v158, v159
    v_mfma_f32_16x16x32_bf16 a[20:23], a[224:227], v[120:123], a[20:23]
    s_waitcnt lgkmcnt(10)
    s_add_u32 s43, s45, 20480
    buffer_store_dwordx4 v[228:231], v59, s[24:27], s43 offen
L_s202:
    v_mfma_f32_16x16x32_bf16 a[24:27], a[228:231], v[112:115], a[24:27]
    s_waitcnt vmcnt(18)
    s_barrier
    s_add_u32 m0, s29, 0
    ds_read_b64_tr_b16 a[224:225], v9 offset:16384
    v_mfma_f32_16x16x32_bf16 a[28:31], a[228:231], v[116:119], a[28:31]
    s_add_u32 s31, s60, 131072
    ds_read_b64_tr_b16 a[226:227], v9 offset:18432
    v_fma_f32 v32, v36, v49, v32
    v_mfma_f32_16x16x32_bf16 a[32:35], a[228:231], v[120:123], a[32:35]
    s_waitcnt lgkmcnt(10)
    v_fma_f32 v33, v37, v51, v33
    v_fma_f32 v34, v38, v61, v34
L_s203:
    v_mfma_f32_16x16x32_bf16 a[36:39], a[204:207], v[112:115], a[36:39]
    ds_read_b64_tr_b16 a[228:229], v10 offset:16384
    ds_read_b64_tr_b16 a[230:231], v10 offset:18432
    v_mfma_f32_16x16x32_bf16 a[40:43], a[204:207], v[116:119], a[40:43]
    buffer_load_dwordx4 v19, s[20:23], s31 offen nt lds
    v_mfma_f32_16x16x32_bf16 a[44:47], a[204:207], v[120:123], a[44:47]
    s_waitcnt lgkmcnt(10)
L_s204:
    v_mfma_f32_16x16x32_bf16 a[0:3], a[208:211], v[136:139], a[0:3]
    s_add_u32 s31, s60, 134144
    ds_read_b64_tr_b16 a[204:205], v11 offset:16384
    ds_read_b64_tr_b16 a[206:207], v11 offset:18432
    v_mfma_f32_16x16x32_bf16 a[4:7], a[208:211], v[140:143], a[4:7]
    v_mfma_f32_16x16x32_bf16 a[8:11], a[208:211], v[144:147], a[8:11]
    s_waitcnt lgkmcnt(10)
L_s205:
    v_mfma_f32_16x16x32_bf16 a[12:15], a[212:215], v[136:139], a[12:15]
    ds_read_b64_tr_b16 a[208:209], v12 offset:16384
    ds_read_b64_tr_b16 a[210:211], v12 offset:18432
    v_mfma_f32_16x16x32_bf16 a[16:19], a[212:215], v[140:143], a[16:19]
    buffer_load_dwordx4 v19, s[20:23], s31 offen offset:1024 nt lds
    v_mfma_f32_16x16x32_bf16 a[20:23], a[212:215], v[144:147], a[20:23]
    s_waitcnt lgkmcnt(10)
L_s206:
    v_mfma_f32_16x16x32_bf16 a[24:27], a[216:219], v[136:139], a[24:27]
    s_add_u32 s31, s60, 145408
    ds_read_b64_tr_b16 a[212:213], v9 offset:20480
    ds_read_b64_tr_b16 a[214:215], v9 offset:22528
    v_mfma_f32_16x16x32_bf16 a[28:31], a[216:219], v[140:143], a[28:31]
    v_mfma_f32_16x16x32_bf16 a[32:35], a[216:219], v[144:147], a[32:35]
    s_waitcnt lgkmcnt(10)
L_s207:
    v_mfma_f32_16x16x32_bf16 a[36:39], a[220:223], v[136:139], a[36:39]
    ds_read_b64_tr_b16 a[216:217], v10 offset:20480
    ds_read_b64_tr_b16 a[218:219], v10 offset:22528
    v_mfma_f32_16x16x32_bf16 a[40:43], a[220:223], v[140:143], a[40:43]
    buffer_load_dwordx4 v19, s[20:23], s31 offen offset:2048 nt lds
    v_mfma_f32_16x16x32_bf16 a[44:47], a[220:223], v[144:147], a[44:47]
    s_waitcnt lgkmcnt(10)
L_s208:
    v_mfma_f32_16x16x32_bf16 a[0:3], a[224:227], v[160:163], a[0:3]
    s_add_u32 s31, s60, 148480
    ds_read_b64_tr_b16 a[220:221], v11 offset:20480
    ds_read_b64_tr_b16 a[222:223], v11 offset:22528
    v_mfma_f32_16x16x32_bf16 a[4:7], a[224:227], v[164:167], a[4:7]
    v_mfma_f32_16x16x32_bf16 a[8:11], a[224:227], v[168:171], a[8:11]
    s_waitcnt lgkmcnt(10)
L_s209:
    v_mfma_f32_16x16x32_bf16 a[12:15], a[228:231], v[160:163], a[12:15]
    ds_read_b64_tr_b16 a[224:225], v12 offset:20480
    ds_read_b64_tr_b16 a[226:227], v12 offset:22528
    v_mfma_f32_16x16x32_bf16 a[16:19], a[228:231], v[164:167], a[16:19]
    buffer_load_dwordx4 v19, s[20:23], s31 offen offset:3072 nt lds
    v_mfma_f32_16x16x32_bf16 a[20:23], a[228:231], v[168:171], a[20:23]
    s_waitcnt lgkmcnt(10)
L_s210:
    v_mfma_f32_16x16x32_bf16 a[24:27], a[204:207], v[160:163], a[24:27]
    s_waitcnt vmcnt(18)
    s_barrier
    s_add_u32 m0, s29, 8192
    ds_read_b64_tr_b16 a[228:229], v9 offset:24576
    ds_read_b64_tr_b16 a[230:231], v9 offset:26624
    v_mfma_f32_16x16x32_bf16 a[28:31], a[204:207], v[164:167], a[28:31]
    s_add_u32 s31, s60, 196608
    v_mfma_f32_16x16x32_bf16 a[32:35], a[204:207], v[168:171], a[32:35]
    s_waitcnt lgkmcnt(10)
L_s211:
    v_mfma_f32_16x16x32_bf16 a[36:39], a[208:211], v[160:163], a[36:39]
    ds_read_b64_tr_b16 a[204:205], v10 offset:24576
    ds_read_b64_tr_b16 a[206:207], v10 offset:26624
    v_mfma_f32_16x16x32_bf16 a[40:43], a[208:211], v[164:167], a[40:43]
    buffer_load_dwordx4 v19, s[20:23], s31 offen nt lds
    v_mfma_f32_16x16x32_bf16 a[44:47], a[208:211], v[168:171], a[44:47]
    s_waitcnt lgkmcnt(10)
L_s212:
    v_mfma_f32_16x16x32_bf16 a[0:3], a[212:215], v[184:187], a[0:3]
    s_add_u32 s31, s60, 199680
    ds_read_b64_tr_b16 a[208:209], v11 offset:24576
    ds_read_b64_tr_b16 a[210:211], v11 offset:26624
    v_mfma_f32_16x16x32_bf16 a[4:7], a[212:215], v[188:191], a[4:7]
    v_mfma_f32_16x16x32_bf16 a[8:11], a[212:215], v[192:195], a[8:11]
    s_waitcnt lgkmcnt(10)
L_s213:
    v_mfma_f32_16x16x32_bf16 a[12:15], a[216:219], v[184:187], a[12:15]
    ds_read_b64_tr_b16 a[212:213], v12 offset:24576
    ds_read_b64_tr_b16 a[214:215], v12 offset:26624
    v_mfma_f32_16x16x32_bf16 a[16:19], a[216:219], v[188:191], a[16:19]
    buffer_load_dwordx4 v19, s[20:23], s31 offen offset:1024 nt lds
    v_mfma_f32_16x16x32_bf16 a[20:23], a[216:219], v[192:195], a[20:23]
    s_waitcnt lgkmcnt(10)
L_s214:
    v_mfma_f32_16x16x32_bf16 a[24:27], a[220:223], v[184:187], a[24:27]
    s_add_u32 s31, s60, 210944
    ds_read_b64_tr_b16 a[216:217], v9 offset:28672
    ds_read_b64_tr_b16 a[218:219], v9 offset:30720
    v_mfma_f32_16x16x32_bf16 a[28:31], a[220:223], v[188:191], a[28:31]
    v_mfma_f32_16x16x32_bf16 a[32:35], a[220:223], v[192:195], a[32:35]
    s_waitcnt lgkmcnt(10)
L_s215:
    v_mfma_f32_16x16x32_bf16 a[36:39], a[224:227], v[184:187], a[36:39]
    ds_read_b64_tr_b16 a[220:221], v10 offset:28672
    ds_read_b64_tr_b16 a[222:223], v10 offset:30720
    v_mfma_f32_16x16x32_bf16 a[40:43], a[224:227], v[188:191], a[40:43]
    buffer_load_dwordx4 v19, s[20:23], s31 offen offset:2048 nt lds
    v_mfma_f32_16x16x32_bf16 a[44:47], a[224:227], v[192:195], a[44:47]
    s_waitcnt lgkmcnt(10)
L_s216:
    v_mfma_f32_16x16x32_bf16 a[0:3], a[228:231], v[208:211], a[0:3]
    s_add_u32 s31, s60, 214016
    ds_read_b64_tr_b16 a[224:225], v11 offset:28672
    ds_read_b64_tr_b16 a[226:227], v11 offset:30720
    v_mfma_f32_16x16x32_bf16 a[4:7], a[228:231], v[212:215], a[4:7]
    v_mfma_f32_16x16x32_bf16 a[8:11], a[228:231], v[216:219], a[8:11]
    s_waitcnt lgkmcnt(10)
L_s217:
    v_mfma_f32_16x16x32_bf16 a[12:15], a[204:207], v[208:211], a[12:15]
    ds_read_b64_tr_b16 a[228:229], v12 offset:28672
    ds_read_b64_tr_b16 a[230:231], v12 offset:30720
    v_mfma_f32_16x16x32_bf16 a[16:19], a[204:207], v[212:215], a[16:19]
    buffer_load_dwordx4 v19, s[20:23], s31 offen offset:3072 nt lds
    v_mfma_f32_16x16x32_bf16 a[20:23], a[204:207], v[216:219], a[20:23]
    s_waitcnt lgkmcnt(10)
L_s218:
    v_mfma_f32_16x16x32_bf16 a[24:27], a[208:211], v[208:211], a[24:27]
    s_waitcnt vmcnt(8)
    s_barrier
    ds_read_b64_tr_b16 a[204:205], v9 offset:32768
    ds_read_b64_tr_b16 a[206:207], v9 offset:34816
    v_mfma_f32_16x16x32_bf16 a[28:31], a[208:211], v[212:215], a[28:31]
    buffer_store_dwordx4 v[28:31], v57, s[48:51], s7 offen sc1
    v_mfma_f32_16x16x32_bf16 a[32:35], a[208:211], v[216:219], a[32:35]
    s_waitcnt lgkmcnt(10)
    buffer_store_dwordx4 v[32:35], v57, s[48:51], s7 offen offset:256 sc1
L_s219:
    v_mfma_f32_16x16x32_bf16 a[36:39], a[212:215], v[208:211], a[36:39]
    ds_read_b64_tr_b16 a[208:209], v10 offset:32768
    ds_read_b64_tr_b16 a[210:211], v10 offset:34816
    v_mfma_f32_16x16x32_bf16 a[40:43], a[212:215], v[212:215], a[40:43]
    v_mfma_f32_16x16x32_bf16 a[44:47], a[212:215], v[216:219], a[44:47]
    s_waitcnt lgkmcnt(10)
L_s220:
    v_mfma_f32_16x16x32_bf16 a[0:3], a[216:219], v[232:235], a[0:3]
    ds_read_b64_tr_b16 a[212:213], v11 offset:32768
    ds_read_b64_tr_b16 a[214:215], v11 offset:34816
    v_mfma_f32_16x16x32_bf16 a[4:7], a[216:219], v[236:239], a[4:7]
    v_mfma_f32_16x16x32_bf16 a[8:11], a[216:219], v[240:243], a[8:11]
    s_waitcnt lgkmcnt(10)
L_s221:
    v_mfma_f32_16x16x32_bf16 a[12:15], a[220:223], v[232:235], a[12:15]
    ds_read_b64_tr_b16 a[216:217], v12 offset:32768
    ds_read_b64_tr_b16 a[218:219], v12 offset:34816
    v_mfma_f32_16x16x32_bf16 a[16:19], a[220:223], v[236:239], a[16:19]
    v_mfma_f32_16x16x32_bf16 a[20:23], a[220:223], v[240:243], a[20:23]
    s_waitcnt lgkmcnt(10)
L_s222:
    v_mfma_f32_16x16x32_bf16 a[24:27], a[224:227], v[232:235], a[24:27]
    ds_read_b64_tr_b16 a[220:221], v9 offset:36864
    ds_read_b64_tr_b16 a[222:223], v9 offset:38912
    v_mfma_f32_16x16x32_bf16 a[28:31], a[224:227], v[236:239], a[28:31]
    v_mfma_f32_16x16x32_bf16 a[32:35], a[224:227], v[240:243], a[32:35]
    s_waitcnt lgkmcnt(10)
L_s223:
    v_mfma_f32_16x16x32_bf16 a[36:39], a[228:231], v[232:235], a[36:39]
    ds_read_b64_tr_b16 a[224:225], v10 offset:36864
    ds_read_b64_tr_b16 a[226:227], v10 offset:38912
    v_mfma_f32_16x16x32_bf16 a[40:43], a[228:231], v[236:239], a[40:43]
    ds_write_b128 v55, a[0:3] offset:0
    v_mfma_f32_16x16x32_bf16 a[44:47], a[228:231], v[240:243], a[44:47]
    s_waitcnt lgkmcnt(11)
L_s224:
    v_mfma_f32_16x16x32_bf16 v[76:79], a[204:207], v[64:67], 0
    ds_read_b64_tr_b16 a[228:229], v11 offset:36864
    ds_read_b64_tr_b16 a[230:231], v11 offset:38912
    v_mfma_f32_16x16x32_bf16 v[80:83], a[204:207], v[68:71], 0
    ds_write_b128 v55, a[4:7] offset:1024
    v_mfma_f32_16x16x32_bf16 v[84:87], a[204:207], v[72:75], 0
    s_waitcnt lgkmcnt(12)
L_s225:
    v_mfma_f32_16x16x32_bf16 v[100:103], a[208:211], v[64:67], 0
    ds_read_b64_tr_b16 a[204:205], v12 offset:36864
    ds_read_b64_tr_b16 a[206:207], v12 offset:38912
    v_mfma_f32_16x16x32_bf16 v[104:107], a[208:211], v[68:71], 0
    ds_write_b128 v55, a[8:11] offset:2048
    v_mfma_f32_16x16x32_bf16 v[108:111], a[208:211], v[72:75], 0
    s_waitcnt lgkmcnt(13)
L_s226:
    v_mfma_f32_16x16x32_bf16 v[124:127], a[212:215], v[64:67], 0
    s_waitcnt vmcnt(11)
    s_barrier
    ds_read_b64_tr_b16 a[208:209], v9 offset:40960
    ds_read_b64_tr_b16 a[210:211], v9 offset:43008
    v_mfma_f32_16x16x32_bf16 v[128:131], a[212:215], v[68:71], 0
    ds_write_b128 v55, a[12:15] offset:3072
    v_mfma_f32_16x16x32_bf16 v[132:135], a[212:215], v[72:75], 0
    s_waitcnt lgkmcnt(14)
L_s227:
    v_mfma_f32_16x16x32_bf16 v[148:151], a[216:219], v[64:67], 0
    ds_read_b64_tr_b16 a[212:213], v10 offset:40960
    ds_read_b64_tr_b16 a[214:215], v10 offset:43008
    v_mfma_f32_16x16x32_bf16 v[152:155], a[216:219], v[68:71], 0
    ds_write_b128 v55, a[16:19] offset:4096
    v_mfma_f32_16x16x32_bf16 v[156:159], a[216:219], v[72:75], 0
    s_waitcnt lgkmcnt(15)
L_s228:
    v_mfma_f32_16x16x32_bf16 v[76:79], a[220:223], v[88:91], v[76:79]
    ds_read_b64_tr_b16 a[216:217], v11 offset:40960
    ds_read_b64_tr_b16 a[218:219], v11 offset:43008
    v_mfma_f32_16x16x32_bf16 v[80:83], a[220:223], v[92:95], v[80:83]
    ds_write_b128 v55, a[20:23] offset:5120
    v_mfma_f32_16x16x32_bf16 v[84:87], a[220:223], v[96:99], v[84:87]
    s_waitcnt lgkmcnt(15)
L_s229:
    v_mfma_f32_16x16x32_bf16 v[100:103], a[224:227], v[88:91], v[100:103]
    ds_read_b64_tr_b16 a[220:221], v12 offset:40960
    ds_read_b64_tr_b16 a[222:223], v12 offset:43008
    v_mfma_f32_16x16x32_bf16 v[104:107], a[224:227], v[92:95], v[104:107]
    ds_write_b128 v55, a[24:27] offset:6144
    v_mfma_f32_16x16x32_bf16 v[108:111], a[224:227], v[96:99], v[108:111]
    s_waitcnt lgkmcnt(15)
L_s230:
    v_mfma_f32_16x16x32_bf16 v[124:127], a[228:231], v[88:91], v[124:127]
    ds_read_b64_tr_b16 a[224:225], v9 offset:45056
    ds_read_b64_tr_b16 a[226:227], v9 offset:47104
    v_mfma_f32_16x16x32_bf16 v[128:131], a[228:231], v[92:95], v[128:131]
    ds_write_b128 v55, a[28:31] offset:7168
    v_mfma_f32_16x16x32_bf16 v[132:135], a[228:231], v[96:99], v[132:135]
    s_waitcnt lgkmcnt(15)
L_s231:
    v_mfma_f32_16x16x32_bf16 v[148:151], a[204:207], v[88:91], v[148:151]
    ds_read_b64_tr_b16 a[228:229], v10 offset:45056
    ds_read_b64_tr_b16 a[230:231], v10 offset:47104
    v_mfma_f32_16x16x32_bf16 v[152:155], a[204:207], v[92:95], v[152:155]
    ds_write_b128 v55, a[32:35] offset:8192
    v_mfma_f32_16x16x32_bf16 v[156:159], a[204:207], v[96:99], v[156:159]
    s_waitcnt lgkmcnt(15)
L_s232:
    v_mfma_f32_16x16x32_bf16 v[76:79], a[208:211], v[112:115], v[76:79]
    ds_read_b64_tr_b16 a[204:205], v11 offset:45056
    ds_read_b64_tr_b16 a[206:207], v11 offset:47104
    v_mfma_f32_16x16x32_bf16 v[80:83], a[208:211], v[116:119], v[80:83]
    ds_write_b128 v55, a[36:39] offset:9216
    v_mfma_f32_16x16x32_bf16 v[84:87], a[208:211], v[120:123], v[84:87]
    s_waitcnt lgkmcnt(15)
L_s233:
    v_mfma_f32_16x16x32_bf16 v[100:103], a[212:215], v[112:115], v[100:103]
    ds_read_b64_tr_b16 a[208:209], v12 offset:45056
    ds_read_b64_tr_b16 a[210:211], v12 offset:47104
    v_mfma_f32_16x16x32_bf16 v[104:107], a[212:215], v[116:119], v[104:107]
    ds_write_b128 v55, a[40:43] offset:10240
    v_mfma_f32_16x16x32_bf16 v[108:111], a[212:215], v[120:123], v[108:111]
    s_waitcnt lgkmcnt(15)
    ds_write_b128 v55, a[44:47] offset:11264
L_s234:
    v_mfma_f32_16x16x32_bf16 v[124:127], a[216:219], v[112:115], v[124:127]
    s_waitcnt vmcnt(6) lgkmcnt(0)
    s_barrier
    ds_read_b64_tr_b16 a[212:213], v9 offset:0
    ds_read_b64_tr_b16 a[214:215], v9 offset:2048
    v_mfma_f32_16x16x32_bf16 v[128:131], a[216:219], v[116:119], v[128:131]
    v_mfma_f32_16x16x32_bf16 v[132:135], a[216:219], v[120:123], v[132:135]
    s_waitcnt lgkmcnt(15)
L_s235:
    v_mfma_f32_16x16x32_bf16 v[148:151], a[220:223], v[112:115], v[148:151]
    ds_read_b64_tr_b16 a[216:217], v10 offset:0
    ds_read_b64_tr_b16 a[218:219], v10 offset:2048
    v_mfma_f32_16x16x32_bf16 v[152:155], a[220:223], v[116:119], v[152:155]
    v_mfma_f32_16x16x32_bf16 v[156:159], a[220:223], v[120:123], v[156:159]
    s_waitcnt lgkmcnt(15)
L_s236:
    v_mfma_f32_16x16x32_bf16 v[76:79], a[224:227], v[136:139], v[76:79]
    ds_read_b64_tr_b16 a[220:221], v11 offset:0
    ds_read_b64_tr_b16 a[222:223], v11 offset:2048
    v_mfma_f32_16x16x32_bf16 v[80:83], a[224:227], v[140:143], v[80:83]
    v_mfma_f32_16x16x32_bf16 v[84:87], a[224:227], v[144:147], v[84:87]
    s_waitcnt lgkmcnt(14)
L_s237:
    v_mfma_f32_16x16x32_bf16 v[100:103], a[228:231], v[136:139], v[100:103]
    ds_read_b64_tr_b16 a[224:225], v12 offset:0
    ds_read_b64_tr_b16 a[226:227], v12 offset:2048
    v_mfma_f32_16x16x32_bf16 v[104:107], a[228:231], v[140:143], v[104:107]
    v_mfma_f32_16x16x32_bf16 v[108:111], a[228:231], v[144:147], v[108:111]
    s_waitcnt lgkmcnt(13)
L_s238:
    v_mfma_f32_16x16x32_bf16 v[124:127], a[204:207], v[136:139], v[124:127]
    ds_read_b64_tr_b16 a[228:229], v9 offset:4096
    ds_read_b64_tr_b16 a[230:231], v9 offset:6144
    v_mfma_f32_16x16x32_bf16 v[128:131], a[204:207], v[140:143], v[128:131]
    v_mfma_f32_16x16x32_bf16 v[132:135], a[204:207], v[144:147], v[132:135]
    s_waitcnt lgkmcnt(12)
L_s239:
    v_mfma_f32_16x16x32_bf16 v[148:151], a[208:211], v[136:139], v[148:151]
    ds_read_b64_tr_b16 a[204:205], v10 offset:4096
    ds_read_b64_tr_b16 a[206:207], v10 offset:6144
    v_mfma_f32_16x16x32_bf16 v[152:155], a[208:211], v[140:143], v[152:155]
    v_mfma_f32_16x16x32_bf16 v[156:159], a[208:211], v[144:147], v[156:159]
    s_waitcnt lgkmcnt(10)
L_s240:
    v_mfma_f32_16x16x32_bf16 v[76:79], a[212:215], v[160:163], v[76:79]
    ds_read_b64_tr_b16 a[208:209], v11 offset:4096
    ds_read_b64_tr_b16 a[210:211], v11 offset:6144
    v_mfma_f32_16x16x32_bf16 v[80:83], a[212:215], v[164:167], v[80:83]
    ds_read_b128 v[64:67], v56 offset:0
    buffer_load_dwordx4 v[40:43], v57, s[48:51], s6 offen sc1
    v_mfma_f32_16x16x32_bf16 v[84:87], a[212:215], v[168:171], v[84:87]
    s_waitcnt lgkmcnt(11)
    ds_read_b128 v[88:91], v56 offset:3072
    buffer_load_dwordx4 v[44:47], v57, s[48:51], s6 offen offset:256 sc1
L_s241:
    v_mfma_f32_16x16x32_bf16 v[100:103], a[216:219], v[160:163], v[100:103]
    ds_read_b64_tr_b16 a[212:213], v12 offset:4096
    ds_read_b64_tr_b16 a[214:215], v12 offset:6144
    v_mfma_f32_16x16x32_bf16 v[104:107], a[216:219], v[164:167], v[104:107]
    ds_read_b128 v[112:115], v56 offset:6144
    v_mfma_f32_16x16x32_bf16 v[108:111], a[216:219], v[168:171], v[108:111]
    s_waitcnt lgkmcnt(13)
    ds_read_b128 v[136:139], v56 offset:9216
L_s242:
    v_mfma_f32_16x16x32_bf16 v[124:127], a[220:223], v[160:163], v[124:127]
    v_mfma_f32_16x16x32_bf16 v[128:131], a[220:223], v[164:167], v[128:131]
    ds_read_b128 v[68:71], v56 offset:1024
    v_mfma_f32_16x16x32_bf16 v[132:135], a[220:223], v[168:171], v[132:135]
    s_waitcnt lgkmcnt(13)
    ds_read_b128 v[92:95], v56 offset:4096
L_s243:
    v_mfma_f32_16x16x32_bf16 v[148:151], a[224:227], v[160:163], v[148:151]
    v_mfma_f32_16x16x32_bf16 v[152:155], a[224:227], v[164:167], v[152:155]
    ds_read_b128 v[116:119], v56 offset:7168
    v_mfma_f32_16x16x32_bf16 v[156:159], a[224:227], v[168:171], v[156:159]
    s_waitcnt lgkmcnt(13)
    ds_read_b128 v[140:143], v56 offset:10240
L_s244:
    v_mfma_f32_16x16x32_bf16 v[76:79], a[228:231], v[184:187], v[76:79]
    v_mfma_f32_16x16x32_bf16 v[80:83], a[228:231], v[188:191], v[80:83]
    ds_read_b128 v[72:75], v56 offset:2048
    v_mfma_f32_16x16x32_bf16 v[84:87], a[228:231], v[192:195], v[84:87]
    s_waitcnt lgkmcnt(13)
    ds_read_b128 v[96:99], v56 offset:5120
L_s245:
    v_mfma_f32_16x16x32_bf16 v[100:103], a[204:207], v[184:187], v[100:103]
    v_mfma_f32_16x16x32_bf16 v[104:107], a[204:207], v[188:191], v[104:107]
    ds_read_b128 v[120:123], v56 offset:8192
    v_mfma_f32_16x16x32_bf16 v[108:111], a[204:207], v[192:195], v[108:111]
    s_waitcnt lgkmcnt(13)
    ds_read_b128 v[144:147], v56 offset:11264
L_s246:
    v_mfma_f32_16x16x32_bf16 v[124:127], a[208:211], v[184:187], v[124:127]
    s_waitcnt vmcnt(4)
    s_barrier
    ds_read_b64_tr_b16 a[216:217], v9 offset:8192
    ds_read_b64_tr_b16 a[218:219], v9 offset:10240
    ds_read_b64_tr_b16 a[220:221], v9 offset:12288
    v_mfma_f32_16x16x32_bf16 v[128:131], a[208:211], v[188:191], v[128:131]
    ds_read_b64_tr_b16 a[222:223], v9 offset:14336
    ds_read_b64_tr_b16 a[224:225], v10 offset:8192
    ds_read_b64_tr_b16 a[226:227], v10 offset:10240
    v_mfma_f32_16x16x32_bf16 v[132:135], a[208:211], v[192:195], v[132:135]
    s_waitcnt lgkmcnt(15)
L_s247:
    v_mfma_f32_16x16x32_bf16 v[148:151], a[212:215], v[184:187], v[148:151]
    ds_read_b64_tr_b16 a[228:229], v10 offset:12288
    ds_read_b64_tr_b16 a[230:231], v10 offset:14336
    v_mfma_f32_16x16x32_bf16 v[152:155], a[212:215], v[188:191], v[152:155]
    ds_read_b64_tr_b16 a[204:205], v11 offset:8192
    ds_read_b64_tr_b16 a[206:207], v11 offset:10240
    v_mfma_f32_16x16x32_bf16 v[156:159], a[212:215], v[192:195], v[156:159]
    s_waitcnt lgkmcnt(8)
    s_waitcnt vmcnt(0) lgkmcnt(10)
    v_xor_b32_e32 v62, v43, v24
    v_xor_b32_e64 v63, v47, v35
    v_or_b32 v62, v62, v63
    v_cmp_ne_u32 vcc, 0, v62
    s_cbranch_vccnz L_retry
L_got:
    s_add_u32 s43, s42, 0
    buffer_load_dwordx4 v[196:199], v59, s[24:27], s43 offen sc1
    s_add_u32 s43, s42, 4096
    buffer_load_dwordx4 v[244:247], v59, s[24:27], s43 offen sc1
    s_add_u32 s43, s42, 8192
    buffer_load_dwordx4 v[200:203], v59, s[24:27], s43 offen sc1
    s_add_u32 s43, s42, 12288
    buffer_load_dwordx4 v[248:251], v59, s[24:27], s43 offen sc1
    s_add_u32 s43, s42, 16384
    buffer_load_dwordx4 v[204:207], v59, s[24:27], s43 offen sc1
    s_add_u32 s43, s42, 20480
    buffer_load_dwordx4 v[252:255], v59, s[24:27], s43 offen sc1
L_invdone:
L_s248:
    v_mfma_f32_16x16x32_bf16 v[76:79], a[216:219], v[208:211], v[76:79]
    ds_read_b64_tr_b16 a[208:209], v11 offset:12288
    ds_read_b64_tr_b16 a[210:211], v11 offset:14336
    v_mfma_f32_16x16x32_bf16 v[80:83], a[216:219], v[212:215], v[80:83]
    ds_read_b64_tr_b16 a[212:213], v12 offset:8192
    ds_read_b64_tr_b16 a[214:215], v12 offset:10240
    v_max_f32_e64 v36, v28, v40
    v_mfma_f32_16x16x32_bf16 v[84:87], a[216:219], v[216:219], v[84:87]
    s_waitcnt lgkmcnt(10)
    v_sub_f32_e32 v37, v28, v36
    v_sub_f32_e64 v40, v40, v36
L_s249:
    v_mfma_f32_16x16x32_bf16 v[76:79], a[220:223], v[232:235], v[76:79]
    ds_read_b64_tr_b16 a[216:217], v12 offset:12288
    ds_read_b64_tr_b16 a[218:219], v12 offset:14336
    v_mfma_f32_16x16x32_bf16 v[80:83], a[220:223], v[236:239], v[80:83]
    v_exp_f32_e64 v37, v37
    v_mfma_f32_16x16x32_bf16 v[84:87], a[220:223], v[240:243], v[84:87]
    s_waitcnt lgkmcnt(10)
    v_exp_f32_e32 v40, v40
L_s250:
    v_mfma_f32_16x16x32_bf16 v[100:103], a[224:227], v[208:211], v[100:103]
    v_mul_f32_e64 v36, v37, v32
    v_fma_f32 v36, v40, v44, v36
    v_mfma_f32_16x16x32_bf16 v[104:107], a[224:227], v[212:215], v[104:107]
    v_rcp_f32_e64 v44, v36
    v_mfma_f32_16x16x32_bf16 v[108:111], a[224:227], v[216:219], v[108:111]
    s_waitcnt lgkmcnt(8)
    v_mul_f32_e32 v37, v37, v44
    v_mul_f32_e64 v40, v40, v44
L_s251:
    v_mfma_f32_16x16x32_bf16 v[100:103], a[228:231], v[232:235], v[100:103]
    v_mul_f32_e64 v36, v37, v48
    v_mul_f32_e64 v37, v37, v49
    v_mfma_f32_16x16x32_bf16 v[104:107], a[228:231], v[236:239], v[104:107]
    v_max_f32_e64 v38, v29, v41
    v_sub_f32_e64 v39, v29, v38
    v_mfma_f32_16x16x32_bf16 v[108:111], a[228:231], v[240:243], v[108:111]
    s_waitcnt lgkmcnt(6)
    v_exp_f32_e32 v39, v39
L_s252:
    v_mfma_f32_16x16x32_bf16 v[124:127], a[204:207], v[208:211], v[124:127]
    v_sub_f32_e64 v41, v41, v38
    v_max_f32_e64 v62, v30, v42
    v_mfma_f32_16x16x32_bf16 v[128:131], a[204:207], v[212:215], v[128:131]
    v_exp_f32_e64 v41, v41
    v_mfma_f32_16x16x32_bf16 v[132:135], a[204:207], v[216:219], v[132:135]
    s_waitcnt lgkmcnt(4)
    v_mul_f32_e32 v38, v39, v33
    v_fma_f32 v38, v41, v45, v38
L_s253:
    v_mfma_f32_16x16x32_bf16 v[124:127], a[208:211], v[232:235], v[124:127]
    v_rcp_f32_e64 v45, v38
    v_mfma_f32_16x16x32_bf16 v[128:131], a[208:211], v[236:239], v[128:131]
    v_mul_f32_e64 v39, v39, v45
    v_mul_f32_e64 v41, v41, v45
    v_mfma_f32_16x16x32_bf16 v[132:135], a[208:211], v[240:243], v[132:135]
    s_waitcnt lgkmcnt(2)
    v_mul_f32_e32 v38, v39, v50
    v_mul_f32_e64 v39, v39, v51
L_s254:
    v_mfma_f32_16x16x32_bf16 v[148:151], a[212:215], v[208:211], v[148:151]
    v_sub_f32_e64 v63, v30, v62
    v_sub_f32_e64 v42, v42, v62
    v_mfma_f32_16x16x32_bf16 v[152:155], a[212:215], v[212:215], v[152:155]
    v_exp_f32_e64 v63, v63
    v_mfma_f32_16x16x32_bf16 v[156:159], a[212:215], v[216:219], v[156:159]
    s_waitcnt lgkmcnt(0)
    v_exp_f32_e32 v42, v42
L_s255:
    v_mfma_f32_16x16x32_bf16 v[148:151], a[216:219], v[232:235], v[148:151]
    v_mul_f32_e64 v62, v63, v34
    v_fma_f32 v62, v42, v46, v62
    v_mfma_f32_16x16x32_bf16 v[152:155], a[216:219], v[236:239], v[152:155]
    v_rcp_f32_e64 v46, v62
    v_mfma_f32_16x16x32_bf16 v[156:159], a[216:219], v[240:243], v[156:159]
    v_mul_f32_e64 v63, v63, v46
    v_mul_f32_e64 v42, v42, v46
    v_mul_f32_e64 v62, v63, v60
    v_mul_f32_e64 v63, v63, v61
    s_mul_i32 s38, s35, 8192
    s_add_u32 s38, s38, 32768
    s_add_u32 s38, s38, s30
    v_and_b32_e32 v1, 15, v0
    v_and_b32_e64 v2, 63, v58
    v_and_b32_e64 v3, 7, v0
    v_lshlrev_b32_e64 v3, 4, v3
    v_xor_b32_e64 v2, v2, v3
    v_lshl_add_u32 v2, v1, 7, v2
    v_add_u32 v55, s38, v2
    v_xor_b32_e64 v25, 64, v55
    v_lshrrev_b32 v1, 3, v0
    v_lshlrev_b32_e64 v2, 4, v1
    v_xor_b32_e64 v2, v2, v3
    v_lshl_add_u32 v2, v1, 7, v2
    v_add_u32 v56, s38, v2
    v_lshrrev_b32 v1, 4, v0
    v_lshlrev_b32_e64 v1, 3, v1
    v_xor_b32_e64 v1, v1, v3
    v_lshlrev_b32_e64 v2, 3, v57
    v_add3_u32 v1, v1, v2, s38
    v_xor_b32_e64 v2, 32, v1
    v_xor_b32_e64 v3, 64, v1
    v_xor_b32 v4, 96, v1
    v_pk_mul_f32 v[64:65], v[64:65], v[36:37] op_sel:[0,1] op_sel_hi:[1,1]
    v_pk_mul_f32 v[66:67], v[66:67], v[36:37] op_sel:[0,1] op_sel_hi:[1,1]
    v_pk_mul_f32 v[88:89], v[88:89], v[36:37] op_sel:[0,1] op_sel_hi:[1,1]
    v_pk_mul_f32 v[90:91], v[90:91], v[36:37] op_sel:[0,1] op_sel_hi:[1,1]
    v_pk_fma_f32 v[64:65], v[76:77], v[36:37], v[64:65] op_sel_hi:[1,0,1]
    v_pk_fma_f32 v[66:67], v[78:79], v[36:37], v[66:67] op_sel_hi:[1,0,1]
    v_pk_fma_f32 v[88:89], v[100:101], v[36:37], v[88:89] op_sel_hi:[1,0,1]
    v_pk_fma_f32 v[90:91], v[102:103], v[36:37], v[90:91] op_sel_hi:[1,0,1]
    v_pk_mul_f32 v[68:69], v[68:69], v[38:39] op_sel:[0,1] op_sel_hi:[1,1]
    v_pk_mul_f32 v[70:71], v[70:71], v[38:39] op_sel:[0,1] op_sel_hi:[1,1]
    v_pk_mul_f32 v[92:93], v[92:93], v[38:39] op_sel:[0,1] op_sel_hi:[1,1]
    v_pk_mul_f32 v[94:95], v[94:95], v[38:39] op_sel:[0,1] op_sel_hi:[1,1]
    v_pk_fma_f32 v[68:69], v[80:81], v[38:39], v[68:69] op_sel_hi:[1,0,1]
    v_pk_fma_f32 v[70:71], v[82:83], v[38:39], v[70:71] op_sel_hi:[1,0,1]
    v_pk_fma_f32 v[92:93], v[104:105], v[38:39], v[92:93] op_sel_hi:[1,0,1]
    v_pk_fma_f32 v[94:95], v[106:107], v[38:39], v[94:95] op_sel_hi:[1,0,1]
    v_pk_mul_f32 v[72:73], v[72:73], v[62:63] op_sel:[0,1] op_sel_hi:[1,1]
    v_pk_mul_f32 v[74:75], v[74:75], v[62:63] op_sel:[0,1] op_sel_hi:[1,1]
    v_pk_mul_f32 v[96:97], v[96:97], v[62:63] op_sel:[0,1] op_sel_hi:[1,1]
    v_pk_mul_f32 v[98:99], v[98:99], v[62:63] op_sel:[0,1] op_sel_hi:[1,1]
    v_pk_fma_f32 v[72:73], v[84:85], v[62:63], v[72:73] op_sel_hi:[1,0,1]
    v_pk_fma_f32 v[74:75], v[86:87], v[62:63], v[74:75] op_sel_hi:[1,0,1]
    v_pk_fma_f32 v[96:97], v[108:109], v[62:63], v[96:97] op_sel_hi:[1,0,1]
    v_pk_fma_f32 v[98:99], v[110:111], v[62:63], v[98:99] op_sel_hi:[1,0,1]
    v_pk_mul_f32 v[112:113], v[112:113], v[36:37] op_sel:[0,1] op_sel_hi:[1,1]
    v_pk_mul_f32 v[114:115], v[114:115], v[36:37] op_sel:[0,1] op_sel_hi:[1,1]
    v_pk_mul_f32 v[136:137], v[136:137], v[36:37] op_sel:[0,1] op_sel_hi:[1,1]
    v_pk_mul_f32 v[138:139], v[138:139], v[36:37] op_sel:[0,1] op_sel_hi:[1,1]
    v_pk_fma_f32 v[112:113], v[124:125], v[36:37], v[112:113] op_sel_hi:[1,0,1]
    v_pk_fma_f32 v[114:115], v[126:127], v[36:37], v[114:115] op_sel_hi:[1,0,1]
    v_pk_fma_f32 v[136:137], v[148:149], v[36:37], v[136:137] op_sel_hi:[1,0,1]
    v_pk_fma_f32 v[138:139], v[150:151], v[36:37], v[138:139] op_sel_hi:[1,0,1]
    v_pk_mul_f32 v[116:117], v[116:117], v[38:39] op_sel:[0,1] op_sel_hi:[1,1]
    v_pk_mul_f32 v[118:119], v[118:119], v[38:39] op_sel:[0,1] op_sel_hi:[1,1]
    v_pk_mul_f32 v[140:141], v[140:141], v[38:39] op_sel:[0,1] op_sel_hi:[1,1]
    v_pk_mul_f32 v[142:143], v[142:143], v[38:39] op_sel:[0,1] op_sel_hi:[1,1]
    v_pk_fma_f32 v[116:117], v[128:129], v[38:39], v[116:117] op_sel_hi:[1,0,1]
    v_pk_fma_f32 v[118:119], v[130:131], v[38:39], v[118:119] op_sel_hi:[1,0,1]
    v_pk_fma_f32 v[140:141], v[152:153], v[38:39], v[140:141] op_sel_hi:[1,0,1]
    v_pk_fma_f32 v[142:143], v[154:155], v[38:39], v[142:143] op_sel_hi:[1,0,1]
    v_pk_mul_f32 v[120:121], v[120:121], v[62:63] op_sel:[0,1] op_sel_hi:[1,1]
    v_pk_mul_f32 v[122:123], v[122:123], v[62:63] op_sel:[0,1] op_sel_hi:[1,1]
    v_pk_mul_f32 v[144:145], v[144:145], v[62:63] op_sel:[0,1] op_sel_hi:[1,1]
    v_pk_mul_f32 v[146:147], v[146:147], v[62:63] op_sel:[0,1] op_sel_hi:[1,1]
    v_pk_fma_f32 v[120:121], v[132:133], v[62:63], v[120:121] op_sel_hi:[1,0,1]
    v_pk_fma_f32 v[122:123], v[134:135], v[62:63], v[122:123] op_sel_hi:[1,0,1]
    v_pk_fma_f32 v[144:145], v[156:157], v[62:63], v[144:145] op_sel_hi:[1,0,1]
    v_pk_fma_f32 v[146:147], v[158:159], v[62:63], v[146:147] op_sel_hi:[1,0,1]
    s_waitcnt vmcnt(5)
    v_lshlrev_b32_e32 v172, 16, v196
    v_and_b32_e64 v173, s8, v196
    v_lshlrev_b32_e64 v174, 16, v197
    v_and_b32_e64 v175, s8, v197
    v_lshlrev_b32_e64 v220, 16, v198
    v_and_b32_e64 v221, s8, v198
    v_lshlrev_b32_e64 v222, 16, v199
    v_and_b32_e64 v223, s8, v199
    v_pk_fma_f32 v[64:65], v[172:173], v[40:41], v[64:65] op_sel:[0,0,0] op_sel_hi:[1,0,1]
    v_pk_fma_f32 v[66:67], v[174:175], v[40:41], v[66:67] op_sel:[0,0,0] op_sel_hi:[1,0,1]
    v_pk_fma_f32 v[88:89], v[220:221], v[40:41], v[88:89] op_sel:[0,0,0] op_sel_hi:[1,0,1]
    v_pk_fma_f32 v[90:91], v[222:223], v[40:41], v[90:91] op_sel:[0,0,0] op_sel_hi:[1,0,1]
    v_cvt_pk_bf16_f32 v76, v64, v65
    v_cvt_pk_bf16_f32 v77, v66, v67
    v_cvt_pk_bf16_f32 v78, v88, v89
    v_cvt_pk_bf16_f32 v79, v90, v91
    ds_write_b64 v1, v[76:77] offset:0
    ds_write_b64 v2, v[78:79] offset:0
    s_waitcnt vmcnt(4)
    v_lshlrev_b32_e32 v176, 16, v244
    v_and_b32_e64 v177, s8, v244
    v_lshlrev_b32_e64 v178, 16, v245
    v_and_b32_e64 v179, s8, v245
    v_lshlrev_b32_e64 v224, 16, v246
    v_and_b32_e64 v225, s8, v246
    v_lshlrev_b32_e64 v226, 16, v247
    v_and_b32_e64 v227, s8, v247
    v_pk_fma_f32 v[112:113], v[176:177], v[40:41], v[112:113] op_sel:[0,0,0] op_sel_hi:[1,0,1]
    v_pk_fma_f32 v[114:115], v[178:179], v[40:41], v[114:115] op_sel:[0,0,0] op_sel_hi:[1,0,1]
    v_pk_fma_f32 v[136:137], v[224:225], v[40:41], v[136:137] op_sel:[0,0,0] op_sel_hi:[1,0,1]
    v_pk_fma_f32 v[138:139], v[226:227], v[40:41], v[138:139] op_sel:[0,0,0] op_sel_hi:[1,0,1]
    v_cvt_pk_bf16_f32 v124, v112, v113
    v_cvt_pk_bf16_f32 v125, v114, v115
    v_cvt_pk_bf16_f32 v126, v136, v137
    v_cvt_pk_bf16_f32 v127, v138, v139
    ds_write_b64 v3, v[124:125] offset:0
    ds_write_b64 v4, v[126:127] offset:0
    ds_read_b128 v[100:103], v56 offset:0
    ds_read_b128 v[148:151], v56 offset:1024
    s_waitcnt vmcnt(3)
    v_lshlrev_b32_e32 v172, 16, v200
    v_and_b32_e64 v173, s8, v200
    v_lshlrev_b32_e64 v174, 16, v201
    v_and_b32_e64 v175, s8, v201
    v_lshlrev_b32_e64 v220, 16, v202
    v_and_b32_e64 v221, s8, v202
    v_lshlrev_b32_e64 v222, 16, v203
    v_and_b32_e64 v223, s8, v203
    v_pk_fma_f32 v[68:69], v[172:173], v[40:41], v[68:69] op_sel:[0,1,0] op_sel_hi:[1,1,1]
    v_pk_fma_f32 v[70:71], v[174:175], v[40:41], v[70:71] op_sel:[0,1,0] op_sel_hi:[1,1,1]
    v_pk_fma_f32 v[92:93], v[220:221], v[40:41], v[92:93] op_sel:[0,1,0] op_sel_hi:[1,1,1]
    v_pk_fma_f32 v[94:95], v[222:223], v[40:41], v[94:95] op_sel:[0,1,0] op_sel_hi:[1,1,1]
    v_cvt_pk_bf16_f32 v80, v68, v69
    v_cvt_pk_bf16_f32 v81, v70, v71
    v_cvt_pk_bf16_f32 v82, v92, v93
    v_cvt_pk_bf16_f32 v83, v94, v95
    ds_write_b64 v1, v[80:81] offset:2048
    ds_write_b64 v2, v[82:83] offset:2048
    s_waitcnt vmcnt(2)
    v_lshlrev_b32_e32 v176, 16, v248
    v_and_b32_e64 v177, s8, v248
    v_lshlrev_b32_e64 v178, 16, v249
    v_and_b32_e64 v179, s8, v249
    v_lshlrev_b32_e64 v224, 16, v250
    v_and_b32_e64 v225, s8, v250
    v_lshlrev_b32_e64 v226, 16, v251
    v_and_b32_e64 v227, s8, v251
    v_pk_fma_f32 v[116:117], v[176:177], v[40:41], v[116:117] op_sel:[0,1,0] op_sel_hi:[1,1,1]
    v_pk_fma_f32 v[118:119], v[178:179], v[40:41], v[118:119] op_sel:[0,1,0] op_sel_hi:[1,1,1]
    v_pk_fma_f32 v[140:141], v[224:225], v[40:41], v[140:141] op_sel:[0,1,0] op_sel_hi:[1,1,1]
    v_pk_fma_f32 v[142:143], v[226:227], v[40:41], v[142:143] op_sel:[0,1,0] op_sel_hi:[1,1,1]
    v_cvt_pk_bf16_f32 v128, v116, v117
    v_cvt_pk_bf16_f32 v129, v118, v119
    v_cvt_pk_bf16_f32 v130, v140, v141
    v_cvt_pk_bf16_f32 v131, v142, v143
    ds_write_b64 v3, v[128:129] offset:2048
    ds_write_b64 v4, v[130:131] offset:2048
    ds_read_b128 v[104:107], v56 offset:2048
    ds_read_b128 v[152:155], v56 offset:3072
    s_waitcnt lgkmcnt(7)
    s_add_u32 s39, s42, 0
    buffer_store_dwordx4 v[100:103], v59, s[24:27], s39 offen
    s_waitcnt lgkmcnt(6)
    s_add_u32 s39, s42, 4096
    buffer_store_dwordx4 v[148:151], v59, s[24:27], s39 offen
    s_waitcnt vmcnt(3)
    v_lshlrev_b32_e64 v172, 16, v204
    v_and_b32_e64 v173, s8, v204
    v_lshlrev_b32_e64 v174, 16, v205
    v_and_b32_e64 v175, s8, v205
    v_lshlrev_b32_e64 v220, 16, v206
    v_and_b32_e64 v221, s8, v206
    v_lshlrev_b32_e64 v222, 16, v207
    v_and_b32_e64 v223, s8, v207
    v_pk_fma_f32 v[72:73], v[172:173], v[42:43], v[72:73] op_sel:[0,0,0] op_sel_hi:[1,0,1]
    v_pk_fma_f32 v[74:75], v[174:175], v[42:43], v[74:75] op_sel:[0,0,0] op_sel_hi:[1,0,1]
    v_pk_fma_f32 v[96:97], v[220:221], v[42:43], v[96:97] op_sel:[0,0,0] op_sel_hi:[1,0,1]
    v_pk_fma_f32 v[98:99], v[222:223], v[42:43], v[98:99] op_sel:[0,0,0] op_sel_hi:[1,0,1]
    v_cvt_pk_bf16_f32 v84, v72, v73
    v_cvt_pk_bf16_f32 v85, v74, v75
    v_cvt_pk_bf16_f32 v86, v96, v97
    v_cvt_pk_bf16_f32 v87, v98, v99
    ds_write_b64 v1, v[84:85] offset:4096
    ds_write_b64 v2, v[86:87] offset:4096
    s_waitcnt vmcnt(2)
    v_lshlrev_b32_e32 v176, 16, v252
    v_and_b32_e64 v177, s8, v252
    v_lshlrev_b32_e64 v178, 16, v253
    v_and_b32_e64 v179, s8, v253
    v_lshlrev_b32_e64 v224, 16, v254
    v_and_b32_e64 v225, s8, v254
    v_lshlrev_b32_e64 v226, 16, v255
    v_and_b32_e64 v227, s8, v255
    v_pk_fma_f32 v[120:121], v[176:177], v[42:43], v[120:121] op_sel:[0,0,0] op_sel_hi:[1,0,1]
    v_pk_fma_f32 v[122:123], v[178:179], v[42:43], v[122:123] op_sel:[0,0,0] op_sel_hi:[1,0,1]
    v_pk_fma_f32 v[144:145], v[224:225], v[42:43], v[144:145] op_sel:[0,0,0] op_sel_hi:[1,0,1]
    v_pk_fma_f32 v[146:147], v[226:227], v[42:43], v[146:147] op_sel:[0,0,0] op_sel_hi:[1,0,1]
    v_cvt_pk_bf16_f32 v132, v120, v121
    v_cvt_pk_bf16_f32 v133, v122, v123
    v_cvt_pk_bf16_f32 v134, v144, v145
    v_cvt_pk_bf16_f32 v135, v146, v147
    ds_write_b64 v3, v[132:133] offset:4096
    ds_write_b64 v4, v[134:135] offset:4096
    ds_read_b128 v[108:111], v56 offset:4096
    ds_read_b128 v[156:159], v56 offset:5120
    s_waitcnt lgkmcnt(7)
    s_add_u32 s39, s42, 8192
    buffer_store_dwordx4 v[104:107], v59, s[24:27], s39 offen
    s_waitcnt lgkmcnt(6)
    s_add_u32 s39, s42, 12288
    buffer_store_dwordx4 v[152:155], v59, s[24:27], s39 offen
    s_waitcnt lgkmcnt(1)
    s_add_u32 s39, s42, 16384
    buffer_store_dwordx4 v[108:111], v59, s[24:27], s39 offen
    s_waitcnt lgkmcnt(0)
    s_add_u32 s39, s42, 20480
    buffer_store_dwordx4 v[156:159], v59, s[24:27], s39 offen
    s_endpgm
L_nonce:
    s_mov_b32 s39, 0x100000
L_nonce2:
    global_load_dword v24, v52, s[56:57] sc1
    s_sub_u32 s39, s39, 1
    s_cmp_eq_u32 s39, 0
    s_waitcnt vmcnt(0)
    s_cbranch_scc1 L_havenonce
    v_cmp_eq_u32 vcc, 0, v24
    s_cbranch_vccnz L_nonce2
    s_branch L_havenonce
L_retry:
    s_mov_b32 s39, 0x80000
L_retry2:
    buffer_load_dwordx4 v[40:43], v57, s[48:51], s6 offen sc1
    buffer_load_dwordx4 v[44:47], v57, s[48:51], s6 offen offset:256 sc1
    s_sub_u32 s39, s39, 1
    s_cmp_eq_u32 s39, 0
    s_waitcnt vmcnt(0)
    s_cbranch_scc1 L_got
    v_xor_b32 v62, v43, v24
    v_xor_b32 v63, v47, v24
    v_lshlrev_b32 v63, 4, v63
    v_or_b32 v62, v62, v63
    v_cmp_ne_u32 vcc, 0, v62
    s_cbranch_vccnz L_retry2
    v_cmp_ne_u32 vcc, v47, v35
    s_cbranch_vccz L_got
    buffer_wbl2 sc1
    s_waitcnt vmcnt(0)
    buffer_store_dword v24, v26, s[48:51], s54 offen sc1
    s_mov_b32 s39, 0x80000
L_rel:
    buffer_load_dword v62, v26, s[48:51], s53 offen sc1
    s_sub_u32 s39, s39, 1
    s_cmp_eq_u32 s39, 0
    s_waitcnt vmcnt(0)
    s_cbranch_scc1 L_inv
    v_cmp_ne_u32 vcc, v62, v24
    s_cbranch_vccnz L_rel
L_inv:
    buffer_inv sc1
    s_waitcnt vmcnt(0)
    s_add_u32 s43, s42, 0
    buffer_load_dwordx4 v[196:199], v59, s[24:27], s43 offen sc1
    s_add_u32 s43, s42, 4096
    buffer_load_dwordx4 v[244:247], v59, s[24:27], s43 offen sc1
    s_add_u32 s43, s42, 8192
    buffer_load_dwordx4 v[200:203], v59, s[24:27], s43 offen sc1
    s_add_u32 s43, s42, 12288
    buffer_load_dwordx4 v[248:251], v59, s[24:27], s43 offen sc1
    s_add_u32 s43, s42, 16384
    buffer_load_dwordx4 v[204:207], v59, s[24:27], s43 offen sc1
    s_add_u32 s43, s42, 20480
    buffer_load_dwordx4 v[252:255], v59, s[24:27], s43 offen sc1
    s_branch L_invdone
L_bump1:
    s_mov_b32 s39, 1
    s_branch L_bump
L_bump3:
    s_mov_b32 s39, 3
    s_branch L_bump
L_bump5:
    s_mov_b32 s39, 5
    s_branch L_bump
L_bump6:
    s_mov_b32 s39, 6
L_bump:
    v_mov_b32 v32, v13
    v_mov_b32 v33, v13
    s_nop 1
    v_permlane32_swap_b32 v32, v33
    v_max_f32 v32, v32, v33
    v_mov_b32 v33, v32
    s_nop 1
    v_permlane16_swap_b32 v32, v33
    v_max_f32 v32, v32, v33
    v_mul_f32 v32, s32, v32
    v_ceil_f32 v32, v32
    v_sub_f32 v28, v16, v32
    v_mov_b32 v16, v32
    v_exp_f32 v28, v28
    v_mov_b32 v32, v14
    v_mov_b32 v33, v14
    s_nop 1
    v_permlane32_swap_b32 v32, v33
    v_max_f32 v32, v32, v33
    v_mov_b32 v33, v32
    s_nop 1
    v_permlane16_swap_b32 v32, v33
    v_max_f32 v32, v32, v33
    v_mul_f32 v32, s32, v32
    v_ceil_f32 v32, v32
    v_sub_f32 v29, v17, v32
    v_mov_b32 v17, v32
    v_exp_f32 v29, v29
    v_mov_b32 v32, v15
    v_mov_b32 v33, v15
    s_nop 1
    v_permlane32_swap_b32 v32, v33
    v_max_f32 v32, v32, v33
    v_mov_b32 v33, v32
    s_nop 1
    v_permlane16_swap_b32 v32, v33
    v_max_f32 v32, v32, v33
    v_mul_f32 v32, s32, v32
    v_ceil_f32 v32, v32
    v_sub_f32 v30, v18, v32
    v_mov_b32 v18, v32
    v_exp_f32 v30, v30
    s_nop 7
    v_accvgpr_read_b32 v32, a192
    v_mul_f32 v32, v32, v28
    v_accvgpr_write_b32 a192, v32
    v_accvgpr_read_b32 v32, a196
    v_mul_f32 v32, v32, v29
    v_accvgpr_write_b32 a196, v32
    v_accvgpr_read_b32 v32, a200
    v_mul_f32 v32, v32, v30
    v_accvgpr_write_b32 a200, v32
    s_cmp_eq_u32 s39, 1
    s_cbranch_scc1 L_fix0
    s_cmp_eq_u32 s39, 3
    s_cbranch_scc1 L_fix2
    s_cmp_eq_u32 s39, 5
    s_cbranch_scc1 L_fix4
L_fix5:
    v_lshlrev_b32 v32, 16, v184
    v_and_b32 v33, s8, v184
    v_mul_f32 v32, v32, v28
    v_mul_f32 v33, v33, v28
    v_cvt_pk_bf16_f32 v184, v32, v33
    v_lshlrev_b32 v32, 16, v185
    v_and_b32 v33, s8, v185
    v_mul_f32 v32, v32, v28
    v_mul_f32 v33, v33, v28
    v_cvt_pk_bf16_f32 v185, v32, v33
    v_lshlrev_b32 v32, 16, v186
    v_and_b32 v33, s8, v186
    v_mul_f32 v32, v32, v28
    v_mul_f32 v33, v33, v28
    v_cvt_pk_bf16_f32 v186, v32, v33
    v_lshlrev_b32 v32, 16, v187
    v_and_b32 v33, s8, v187
    v_mul_f32 v32, v32, v28
    v_mul_f32 v33, v33, v28
    v_cvt_pk_bf16_f32 v187, v32, v33
    v_lshlrev_b32 v32, 16, v188
    v_and_b32 v33, s8, v188
    v_mul_f32 v32, v32, v29
    v_mul_f32 v33, v33, v29
    v_cvt_pk_bf16_f32 v188, v32, v33
    v_lshlrev_b32 v32, 16, v189
    v_and_b32 v33, s8, v189
    v_mul_f32 v32, v32, v29
    v_mul_f32 v33, v33, v29
    v_cvt_pk_bf16_f32 v189, v32, v33
    v_lshlrev_b32 v32, 16, v190
    v_and_b32 v33, s8, v190
    v_mul_f32 v32, v32, v29
    v_mul_f32 v33, v33, v29
    v_cvt_pk_bf16_f32 v190, v32, v33
    v_lshlrev_b32 v32, 16, v191
    v_and_b32 v33, s8, v191
    v_mul_f32 v32, v32, v29
    v_mul_f32 v33, v33, v29
    v_cvt_pk_bf16_f32 v191, v32, v33
    v_lshlrev_b32 v32, 16, v192
    v_and_b32 v33, s8, v192
    v_mul_f32 v32, v32, v30
    v_mul_f32 v33, v33, v30
    v_cvt_pk_bf16_f32 v192, v32, v33
    v_lshlrev_b32 v32, 16, v193
    v_and_b32 v33, s8, v193
    v_mul_f32 v32, v32, v30
    v_mul_f32 v33, v33, v30
    v_cvt_pk_bf16_f32 v193, v32, v33
    v_lshlrev_b32 v32, 16, v194
    v_and_b32 v33, s8, v194
    v_mul_f32 v32, v32, v30
    v_mul_f32 v33, v33, v30
    v_cvt_pk_bf16_f32 v194, v32, v33
    v_lshlrev_b32 v32, 16, v195
    v_and_b32 v33, s8, v195
    v_mul_f32 v32, v32, v30
    v_mul_f32 v33, v33, v30
    v_cvt_pk_bf16_f32 v195, v32, v33
L_fix4:
    v_lshlrev_b32 v32, 16, v160
    v_and_b32 v33, s8, v160
    v_mul_f32 v32, v32, v28
    v_mul_f32 v33, v33, v28
    v_cvt_pk_bf16_f32 v160, v32, v33
    v_lshlrev_b32 v32, 16, v161
    v_and_b32 v33, s8, v161
    v_mul_f32 v32, v32, v28
    v_mul_f32 v33, v33, v28
    v_cvt_pk_bf16_f32 v161, v32, v33
    v_lshlrev_b32 v32, 16, v162
    v_and_b32 v33, s8, v162
    v_mul_f32 v32, v32, v28
    v_mul_f32 v33, v33, v28
    v_cvt_pk_bf16_f32 v162, v32, v33
    v_lshlrev_b32 v32, 16, v163
    v_and_b32 v33, s8, v163
    v_mul_f32 v32, v32, v28
    v_mul_f32 v33, v33, v28
    v_cvt_pk_bf16_f32 v163, v32, v33
    v_lshlrev_b32 v32, 16, v164
    v_and_b32 v33, s8, v164
    v_mul_f32 v32, v32, v29
    v_mul_f32 v33, v33, v29
    v_cvt_pk_bf16_f32 v164, v32, v33
    v_lshlrev_b32 v32, 16, v165
    v_and_b32 v33, s8, v165
    v_mul_f32 v32, v32, v29
    v_mul_f32 v33, v33, v29
    v_cvt_pk_bf16_f32 v165, v32, v33
    v_lshlrev_b32 v32, 16, v166
    v_and_b32 v33, s8, v166
    v_mul_f32 v32, v32, v29
    v_mul_f32 v33, v33, v29
    v_cvt_pk_bf16_f32 v166, v32, v33
    v_lshlrev_b32 v32, 16, v167
    v_and_b32 v33, s8, v167
    v_mul_f32 v32, v32, v29
    v_mul_f32 v33, v33, v29
    v_cvt_pk_bf16_f32 v167, v32, v33
    v_lshlrev_b32 v32, 16, v168
    v_and_b32 v33, s8, v168
    v_mul_f32 v32, v32, v30
    v_mul_f32 v33, v33, v30
    v_cvt_pk_bf16_f32 v168, v32, v33
    v_lshlrev_b32 v32, 16, v169
    v_and_b32 v33, s8, v169
    v_mul_f32 v32, v32, v30
    v_mul_f32 v33, v33, v30
    v_cvt_pk_bf16_f32 v169, v32, v33
    v_lshlrev_b32 v32, 16, v170
    v_and_b32 v33, s8, v170
    v_mul_f32 v32, v32, v30
    v_mul_f32 v33, v33, v30
    v_cvt_pk_bf16_f32 v170, v32, v33
    v_lshlrev_b32 v32, 16, v171
    v_and_b32 v33, s8, v171
    v_mul_f32 v32, v32, v30
    v_mul_f32 v33, v33, v30
    v_cvt_pk_bf16_f32 v171, v32, v33
L_fix3:
    v_lshlrev_b32 v32, 16, v136
    v_and_b32 v33, s8, v136
    v_mul_f32 v32, v32, v28
    v_mul_f32 v33, v33, v28
    v_cvt_pk_bf16_f32 v136, v32, v33
    v_lshlrev_b32 v32, 16, v137
    v_and_b32 v33, s8, v137
    v_mul_f32 v32, v32, v28
    v_mul_f32 v33, v33, v28
    v_cvt_pk_bf16_f32 v137, v32, v33
    v_lshlrev_b32 v32, 16, v138
    v_and_b32 v33, s8, v138
    v_mul_f32 v32, v32, v28
    v_mul_f32 v33, v33, v28
    v_cvt_pk_bf16_f32 v138, v32, v33
    v_lshlrev_b32 v32, 16, v139
    v_and_b32 v33, s8, v139
    v_mul_f32 v32, v32, v28
    v_mul_f32 v33, v33, v28
    v_cvt_pk_bf16_f32 v139, v32, v33
    v_lshlrev_b32 v32, 16, v140
    v_and_b32 v33, s8, v140
    v_mul_f32 v32, v32, v29
    v_mul_f32 v33, v33, v29
    v_cvt_pk_bf16_f32 v140, v32, v33
    v_lshlrev_b32 v32, 16, v141
    v_and_b32 v33, s8, v141
    v_mul_f32 v32, v32, v29
    v_mul_f32 v33, v33, v29
    v_cvt_pk_bf16_f32 v141, v32, v33
    v_lshlrev_b32 v32, 16, v142
    v_and_b32 v33, s8, v142
    v_mul_f32 v32, v32, v29
    v_mul_f32 v33, v33, v29
    v_cvt_pk_bf16_f32 v142, v32, v33
    v_lshlrev_b32 v32, 16, v143
    v_and_b32 v33, s8, v143
    v_mul_f32 v32, v32, v29
    v_mul_f32 v33, v33, v29
    v_cvt_pk_bf16_f32 v143, v32, v33
    v_lshlrev_b32 v32, 16, v144
    v_and_b32 v33, s8, v144
    v_mul_f32 v32, v32, v30
    v_mul_f32 v33, v33, v30
    v_cvt_pk_bf16_f32 v144, v32, v33
    v_lshlrev_b32 v32, 16, v145
    v_and_b32 v33, s8, v145
    v_mul_f32 v32, v32, v30
    v_mul_f32 v33, v33, v30
    v_cvt_pk_bf16_f32 v145, v32, v33
    v_lshlrev_b32 v32, 16, v146
    v_and_b32 v33, s8, v146
    v_mul_f32 v32, v32, v30
    v_mul_f32 v33, v33, v30
    v_cvt_pk_bf16_f32 v146, v32, v33
    v_lshlrev_b32 v32, 16, v147
    v_and_b32 v33, s8, v147
    v_mul_f32 v32, v32, v30
    v_mul_f32 v33, v33, v30
    v_cvt_pk_bf16_f32 v147, v32, v33
L_fix2:
    v_lshlrev_b32 v32, 16, v112
    v_and_b32 v33, s8, v112
    v_mul_f32 v32, v32, v28
    v_mul_f32 v33, v33, v28
    v_cvt_pk_bf16_f32 v112, v32, v33
    v_lshlrev_b32 v32, 16, v113
    v_and_b32 v33, s8, v113
    v_mul_f32 v32, v32, v28
    v_mul_f32 v33, v33, v28
    v_cvt_pk_bf16_f32 v113, v32, v33
    v_lshlrev_b32 v32, 16, v114
    v_and_b32 v33, s8, v114
    v_mul_f32 v32, v32, v28
    v_mul_f32 v33, v33, v28
    v_cvt_pk_bf16_f32 v114, v32, v33
    v_lshlrev_b32 v32, 16, v115
    v_and_b32 v33, s8, v115
    v_mul_f32 v32, v32, v28
    v_mul_f32 v33, v33, v28
    v_cvt_pk_bf16_f32 v115, v32, v33
    v_lshlrev_b32 v32, 16, v116
    v_and_b32 v33, s8, v116
    v_mul_f32 v32, v32, v29
    v_mul_f32 v33, v33, v29
    v_cvt_pk_bf16_f32 v116, v32, v33
    v_lshlrev_b32 v32, 16, v117
    v_and_b32 v33, s8, v117
    v_mul_f32 v32, v32, v29
    v_mul_f32 v33, v33, v29
    v_cvt_pk_bf16_f32 v117, v32, v33
    v_lshlrev_b32 v32, 16, v118
    v_and_b32 v33, s8, v118
    v_mul_f32 v32, v32, v29
    v_mul_f32 v33, v33, v29
    v_cvt_pk_bf16_f32 v118, v32, v33
    v_lshlrev_b32 v32, 16, v119
    v_and_b32 v33, s8, v119
    v_mul_f32 v32, v32, v29
    v_mul_f32 v33, v33, v29
    v_cvt_pk_bf16_f32 v119, v32, v33
    v_lshlrev_b32 v32, 16, v120
    v_and_b32 v33, s8, v120
    v_mul_f32 v32, v32, v30
    v_mul_f32 v33, v33, v30
    v_cvt_pk_bf16_f32 v120, v32, v33
    v_lshlrev_b32 v32, 16, v121
    v_and_b32 v33, s8, v121
    v_mul_f32 v32, v32, v30
    v_mul_f32 v33, v33, v30
    v_cvt_pk_bf16_f32 v121, v32, v33
    v_lshlrev_b32 v32, 16, v122
    v_and_b32 v33, s8, v122
    v_mul_f32 v32, v32, v30
    v_mul_f32 v33, v33, v30
    v_cvt_pk_bf16_f32 v122, v32, v33
    v_lshlrev_b32 v32, 16, v123
    v_and_b32 v33, s8, v123
    v_mul_f32 v32, v32, v30
    v_mul_f32 v33, v33, v30
    v_cvt_pk_bf16_f32 v123, v32, v33
L_fix1:
    v_lshlrev_b32 v32, 16, v88
    v_and_b32 v33, s8, v88
    v_mul_f32 v32, v32, v28
    v_mul_f32 v33, v33, v28
    v_cvt_pk_bf16_f32 v88, v32, v33
    v_lshlrev_b32 v32, 16, v89
    v_and_b32 v33, s8, v89
    v_mul_f32 v32, v32, v28
    v_mul_f32 v33, v33, v28
    v_cvt_pk_bf16_f32 v89, v32, v33
    v_lshlrev_b32 v32, 16, v90
    v_and_b32 v33, s8, v90
    v_mul_f32 v32, v32, v28
    v_mul_f32 v33, v33, v28
    v_cvt_pk_bf16_f32 v90, v32, v33
    v_lshlrev_b32 v32, 16, v91
    v_and_b32 v33, s8, v91
    v_mul_f32 v32, v32, v28
    v_mul_f32 v33, v33, v28
    v_cvt_pk_bf16_f32 v91, v32, v33
    v_lshlrev_b32 v32, 16, v92
    v_and_b32 v33, s8, v92
    v_mul_f32 v32, v32, v29
    v_mul_f32 v33, v33, v29
    v_cvt_pk_bf16_f32 v92, v32, v33
    v_lshlrev_b32 v32, 16, v93
    v_and_b32 v33, s8, v93
    v_mul_f32 v32, v32, v29
    v_mul_f32 v33, v33, v29
    v_cvt_pk_bf16_f32 v93, v32, v33
    v_lshlrev_b32 v32, 16, v94
    v_and_b32 v33, s8, v94
    v_mul_f32 v32, v32, v29
    v_mul_f32 v33, v33, v29
    v_cvt_pk_bf16_f32 v94, v32, v33
    v_lshlrev_b32 v32, 16, v95
    v_and_b32 v33, s8, v95
    v_mul_f32 v32, v32, v29
    v_mul_f32 v33, v33, v29
    v_cvt_pk_bf16_f32 v95, v32, v33
    v_lshlrev_b32 v32, 16, v96
    v_and_b32 v33, s8, v96
    v_mul_f32 v32, v32, v30
    v_mul_f32 v33, v33, v30
    v_cvt_pk_bf16_f32 v96, v32, v33
    v_lshlrev_b32 v32, 16, v97
    v_and_b32 v33, s8, v97
    v_mul_f32 v32, v32, v30
    v_mul_f32 v33, v33, v30
    v_cvt_pk_bf16_f32 v97, v32, v33
    v_lshlrev_b32 v32, 16, v98
    v_and_b32 v33, s8, v98
    v_mul_f32 v32, v32, v30
    v_mul_f32 v33, v33, v30
    v_cvt_pk_bf16_f32 v98, v32, v33
    v_lshlrev_b32 v32, 16, v99
    v_and_b32 v33, s8, v99
    v_mul_f32 v32, v32, v30
    v_mul_f32 v33, v33, v30
    v_cvt_pk_bf16_f32 v99, v32, v33
L_fix0:
    v_lshlrev_b32 v32, 16, v64
    v_and_b32 v33, s8, v64
    v_mul_f32 v32, v32, v28
    v_mul_f32 v33, v33, v28
    v_cvt_pk_bf16_f32 v64, v32, v33
    v_lshlrev_b32 v32, 16, v65
    v_and_b32 v33, s8, v65
    v_mul_f32 v32, v32, v28
    v_mul_f32 v33, v33, v28
    v_cvt_pk_bf16_f32 v65, v32, v33
    v_lshlrev_b32 v32, 16, v66
    v_and_b32 v33, s8, v66
    v_mul_f32 v32, v32, v28
    v_mul_f32 v33, v33, v28
    v_cvt_pk_bf16_f32 v66, v32, v33
    v_lshlrev_b32 v32, 16, v67
    v_and_b32 v33, s8, v67
    v_mul_f32 v32, v32, v28
    v_mul_f32 v33, v33, v28
    v_cvt_pk_bf16_f32 v67, v32, v33
    v_lshlrev_b32 v32, 16, v68
    v_and_b32 v33, s8, v68
    v_mul_f32 v32, v32, v29
    v_mul_f32 v33, v33, v29
    v_cvt_pk_bf16_f32 v68, v32, v33
    v_lshlrev_b32 v32, 16, v69
    v_and_b32 v33, s8, v69
    v_mul_f32 v32, v32, v29
    v_mul_f32 v33, v33, v29
    v_cvt_pk_bf16_f32 v69, v32, v33
    v_lshlrev_b32 v32, 16, v70
    v_and_b32 v33, s8, v70
    v_mul_f32 v32, v32, v29
    v_mul_f32 v33, v33, v29
    v_cvt_pk_bf16_f32 v70, v32, v33
    v_lshlrev_b32 v32, 16, v71
    v_and_b32 v33, s8, v71
    v_mul_f32 v32, v32, v29
    v_mul_f32 v33, v33, v29
    v_cvt_pk_bf16_f32 v71, v32, v33
    v_lshlrev_b32 v32, 16, v72
    v_and_b32 v33, s8, v72
    v_mul_f32 v32, v32, v30
    v_mul_f32 v33, v33, v30
    v_cvt_pk_bf16_f32 v72, v32, v33
    v_lshlrev_b32 v32, 16, v73
    v_and_b32 v33, s8, v73
    v_mul_f32 v32, v32, v30
    v_mul_f32 v33, v33, v30
    v_cvt_pk_bf16_f32 v73, v32, v33
    v_lshlrev_b32 v32, 16, v74
    v_and_b32 v33, s8, v74
    v_mul_f32 v32, v32, v30
    v_mul_f32 v33, v33, v30
    v_cvt_pk_bf16_f32 v74, v32, v33
    v_lshlrev_b32 v32, 16, v75
    v_and_b32 v33, s8, v75
    v_mul_f32 v32, v32, v30
    v_mul_f32 v33, v33, v30
    v_cvt_pk_bf16_f32 v75, v32, v33
    s_nop 1
    s_cmp_eq_u32 s39, 1
    s_cbranch_scc1 L_back1
    s_cmp_eq_u32 s39, 3
    s_cbranch_scc1 L_back3
    s_cmp_eq_u32 s39, 5
    s_cbranch_scc1 L_back5
    s_branch L_back6
L_end:
    s_endpgm
.section .rodata,"a"
.p2align 6
.amdhsa_kernel standalone__gqa_softmax__near_ridge_kernel
  .amdhsa_next_free_vgpr 512
  .amdhsa_next_free_sgpr 64
  .amdhsa_accum_offset 256
  .amdhsa_group_segment_fixed_size 0
  .amdhsa_kernarg_size 48
  .amdhsa_user_sgpr_count 2
  .amdhsa_user_sgpr_kernarg_segment_ptr 1
  .amdhsa_system_sgpr_workgroup_id_x 1
.end_amdhsa_kernel
```
